```python
import torch

def _softmax(x, axis=-1):
    return torch.softmax(x, dim=axis)
def _gelu(x):
    return torch.nn.functional.gelu(x, approximate="tanh")
def _silu(x):
    return torch.nn.functional.silu(x)
def _sigmoid(x):
    return torch.sigmoid(x)
def _layernorm(x, axis=-1, eps=1e-5):
    m = x.mean(dim=axis, keepdim=True)
    v = x.var(dim=axis, keepdim=True, unbiased=False)
    return (x - m) / torch.sqrt(v + eps)
def _scatter_add(tgt, idx, src, axis=0):
    return tgt.clone().index_add_(axis, idx, src)
def _segment_sum(src, seg, n):
    out = torch.zeros((n,) + src.shape[1:], dtype=src.dtype)
    return out.index_add_(0, seg, src)
def _pad(x, pw):
    flat = tuple(v for pair in reversed(pw) for v in pair)
    return torch.nn.functional.pad(x, flat)

kernel_name = 'sequential_preLN__spectral_gfnet__dense_activation_squared_relu__prompt'

def setup_inputs():

    _w = (lambda a: (lambda t: t.to(torch.bfloat16) if t.is_floating_point() else t)(torch.as_tensor(a)))
    def _A_setup():
        B, S, D = 1, 2048, 640
        Df = D // 2 + 1
        return {
            "x": _w((lambda *s: torch.randn(*s, dtype=torch.bfloat16) * 0.05)(B, S, D)),
            "w_r": _w((lambda *s: torch.randn(*s, dtype=torch.bfloat16) * 0.4)(S, Df) * 0.02),
            "w_i": _w((lambda *s: torch.randn(*s, dtype=torch.bfloat16) * 0.4)(S, Df) * 0.02),
        }
    _A_in = _A_setup()

    def _B_setup():
        B, S, D, F = 1, 2048, 640, 1728
        return {
            "x": _w((lambda *s: torch.randn(*s, dtype=torch.bfloat16) * 0.05)(B, S, D)),
            "w1": _w((lambda *s: torch.randn(*s, dtype=torch.bfloat16) * 0.05)(D, F)),
            "b1": _w((lambda *s: torch.randn(*s, dtype=torch.bfloat16) * 0.2)(F)),
            "w2": _w((lambda *s: torch.randn(*s, dtype=torch.bfloat16) * 0.05)(F, D)),
            "b2": _w((lambda *s: torch.randn(*s, dtype=torch.bfloat16) * 1.6)(D)),
        }
    _B_in = _B_setup()

    return {
        "A_x": _A_in["x"],
        "A_w_r": _A_in["w_r"],
        "A_w_i": _A_in["w_i"],
        "B_x": _B_in["x"],
        "B_w1": _B_in["w1"],
        "B_b1": _B_in["b1"],
        "B_w2": _B_in["w2"],
        "B_b2": _B_in["b2"],
    }

def reference(A_x, A_w_r, A_w_i, B_x, B_w1, B_b1, B_w2, B_b2):
    def _A_ref(x, w_r, w_i):
        B, S, D = x.shape
        X = (lambda x, axes=(-2,-1): torch.fft.rfft2(x.float(), dim=axes))(x, axes=(-2, -1))
        W = w_r + 1j * w_i
        X = X * W
        y = (lambda x, s, axes=(-2,-1): torch.fft.irfft2(x, s=s, dim=axes).to(torch.bfloat16))(X, (S, D), axes=(-2, -1))
        return y

    def _B_ref(x, w1, b1, w2, b2):
        h = torch.einsum("bsd,df->bsf", x, w1) + b1
        zero = torch.zeros_like(h)
        r = torch.where(h > zero, h, zero)
        h = r * r
        out = torch.einsum("bsf,fd->bsd", h, w2) + b2
        return out

    x = A_x
    h = x + _A_ref(_layernorm(x, axis=-1), A_w_r, A_w_i)
    h2 = h + _B_ref(_layernorm(h, axis=-1), B_w1, B_b1, B_w2, B_b2)
    return h2
```

```asm
; @launch kernel=k1_kernel grid=(256,1,1) block=(256,1,1) lds=37376
; @launch kernel=kf_kernel grid=(256,1,1) block=(256,1,1) lds=163840
.amdgcn_target "amdgcn-amd-amdhsa--gfx950"
.text
.globl k1_kernel
.p2align 8
.type k1_kernel,@function
k1_kernel:
    s_load_dwordx4 s[4:7], s[0:1], 0
    s_load_dwordx2 s[16:17], s[0:1], 16
    s_load_dwordx2 s[18:19], s[0:1], 80
    v_lshrrev_b32 v2, 6, v0
    v_and_b32 v1, 63, v0
    v_readfirstlane_b32 s20, v2
    s_cmp_ge_u32 s2, 256
    s_nop 2
    s_cbranch_scc1 K1_end
    s_lshr_b32 s21, s2, 3
    s_getpc_b64 s[30:31]
K1_PC:
    s_add_u32 s30, s30, k1_kernel-K1_PC
    s_addc_u32 s31, s31, -1
    s_lshl_b32 s24, s21, 2
    s_add_u32 s24, s24, s20
    s_lshl_b32 s24, s24, 9
    v_lshl_add_u32 v56, v1, 7, s24
    v_min_u32 v56, CODE_END-k1_kernel, v56
    s_mov_b64 exec, 15
    global_load_dword v127, v56, s[30:31]
    s_mov_b64 exec, -1
    s_and_b32 s22, s2, 7
    s_lshr_b32 s23, s22, 1
    s_lshl_b32 s23, s23, 4
    s_and_b32 s24, s22, 1
    s_lshl_b32 s24, s24, 2
    s_add_u32 s23, s23, s24
    s_lshr_b32 s24, s20, 1
    s_lshl_b32 s24, s24, 3
    s_add_u32 s23, s23, s24
    s_and_b32 s24, s20, 1
    s_lshl_b32 s24, s24, 1
    s_add_u32 s23, s23, s24
    s_lshl_b32 s23, s23, 5
    s_add_u32 s23, s23, s21
    s_mul_i32 s23, s23, 1280
    v_lshrrev_b32 v55, 5, v1
    v_and_b32 v53, 31, v1
    v_mul_u32_u24 v54, 0xa000, v55
    v_add_u32 v52, 1, v53
    v_and_b32 v52, 31, v52
    v_mad_u32_u24 v56, v53, 40, v54
    v_mad_u32_u24 v57, v52, 40, v54
    s_waitcnt lgkmcnt(0)
    s_mov_b32 s8, s4
    s_mov_b32 s9, s5
    s_mov_b32 s10, 2621440
    s_mov_b32 s11, 0x20000
    buffer_load_dwordx4 v[2:5], v56, s[8:11], s23 offen
    buffer_load_dwordx4 v[6:9], v56, s[8:11], s23 offen offset:16
    buffer_load_dwordx2 v[10:11], v56, s[8:11], s23 offen offset:32
    buffer_load_dwordx4 v[12:15], v57, s[8:11], s23 offen
    buffer_load_dwordx2 v[16:17], v57, s[8:11], s23 offen offset:16
    s_mov_b32 s12, s18
    s_mov_b32 s13, s19
    s_mov_b32 s14, 2662400
    s_mov_b32 s15, 0x20000
    s_mov_b32 s70, 12288
    s_mov_b32 s48, s6
    s_mov_b32 s49, s7
    s_mov_b32 s50, 1314816
    s_mov_b32 s51, 0x20000
    s_mov_b32 s52, s16
    s_mov_b32 s53, s17
    s_mov_b32 s54, 1314816
    s_mov_b32 s55, 0x20000
    s_add_u32 s56, s18, 2686976
    s_addc_u32 s57, s19, 0
    s_mov_b32 s58, 2662400
    s_mov_b32 s59, 0x20000
    s_lshr_b32 s60, s21, 1
    s_lshl_b32 s60, s60, 2
    s_lshl_b32 s61, s22, 8
    s_add_u32 s61, s61, s60
    s_add_u32 s61, s61, s20
    s_mul_i32 s64, s61, 642
    s_add_u32 s65, s64, 41088
    s_add_u32 s66, s65, 41088
    s_add_u32 s67, s66, 41088
    s_and_b32 s61, s21, 1
    s_mul_i32 s61, s61, 160
    v_add_u32 v128, s61, v1
    v_lshlrev_b32 v129, 1, v128
    v_cmp_eq_u32 vcc, 0, v128
    v_mov_b32 v130, 0x280
    s_nop 0
    v_cndmask_b32 v130, v129, v130, vcc
    s_lshl_b32 s63, s20, 4
    s_add_u32 s63, s63, 12288
    v_mul_u32_u24 v157, 80, v1
    v_add_u32 v157, s63, v157
    s_mul_i32 s63, s20, 40
    v_lshrrev_b32 v128, 2, v1
    v_add_u32 v128, s63, v128
    v_and_b32 v156, 3, v1
    v_lshlrev_b32 v156, 4, v156
    v_mul_u32_u24 v158, 80, v128
    v_add3_u32 v158, v158, v156, s70
    v_add_u32 v128, s61, v128
    v_mul_u32_u24 v131, 8320, v128
    v_add_u32 v131, v156, v131
    s_lshr_b32 s62, s60, 5
    s_lshl_b32 s62, s62, 12
    s_lshl_b32 s63, s22, 9
    s_add_u32 s62, s62, s63
    s_and_b32 s63, s60, 31
    s_lshl_b32 s63, s63, 4
    s_add_u32 s62, s62, s63
    s_add_u32 s63, s62, 133120
    s_add_u32 s68, s63, 133120
    v_lshlrev_b32 v53, 3, v53
    s_lshl_b32 s24, s20, 6
    v_lshl_add_u32 v54, v55, 4, s24
    v_add_u32 v52, 32, v54
    v_add_u32 v56, 0, v53
    v_and_b32 v56, 0xf8, v56
    v_xor_b32 v57, v56, v54
    v_and_b32 v56, 0xf0, v56
    v_lshl_add_u32 v120, v56, 4, v57
    v_add_u32 v56, 160, v53
    v_and_b32 v56, 0xf8, v56
    v_xor_b32 v57, v56, v54
    v_and_b32 v56, 0xf0, v56
    v_lshl_add_u32 v121, v56, 4, v57
    v_add_u32 v56, 56, v53
    v_and_b32 v56, 0xf8, v56
    v_xor_b32 v57, v56, v54
    v_and_b32 v56, 0xf0, v56
    v_lshl_add_u32 v122, v56, 4, v57
    v_add_u32 v56, 208, v53
    v_and_b32 v56, 0xf8, v56
    v_xor_b32 v57, v56, v52
    v_and_b32 v56, 0xf0, v56
    v_lshl_add_u32 v123, v56, 4, v57
    v_add_u32 v56, 104, v53
    v_and_b32 v56, 0xf8, v56
    v_xor_b32 v57, v56, v52
    v_and_b32 v56, 0xf0, v56
    v_lshl_add_u32 v124, v56, 4, v57
    v_and_b32 v53, 15, v1
    v_lshrrev_b32 v56, 4, v1
    v_xor_b32 v54, v53, v56
    v_lshlrev_b32 v54, 4, v54
    v_lshl_add_u32 v62, v56, 8, v54
    v_xor_b32 v63, 64, v62
    v_xor_b32 v125, 0x80, v62
    v_xor_b32 v126, 0xc0, v62
    s_lshl_b32 s24, s20, 4
    v_add_u32 v18, s24, v53
    s_lshl_b32 s25, s22, 10
    s_lshl_b32 s26, s21, 5
    s_add_u32 s25, s25, s26
    v_and_b32 v19, 16, v1
    v_add_u32 v19, s25, v19
    s_mov_b32 s26, 8320
    v_cvt_f32_u32 v96, v18
    v_mul_f32 v96, 0xbc000000, v96
    v_cvt_f32_u32 v97, v56
    v_mul_f32 v97, v97, v96
    v_mul_f32 v97, 0x41000000, v97
    v_mul_f32 v98, 0x41c80000, v96
    s_mov_b32 s28, 0x24130
    s_mov_b32 s29, 10668340
    v_mul_u32_u24 v100, 52, v18
    v_lshrrev_b32 v100, 8, v100
    v_mul_u32_u24 v100, 5, v100
    v_sub_u32 v100, v18, v100
    v_mul_u32_u24 v101, 5, v100
    v_lshrrev_b32 v101, v101, s29
    v_bfe_i32 v57, v101, 0, 1
    v_and_b32 v57, 0x80008000, v57
    v_bfe_i32 v58, v101, 1, 1
    v_and_b32 v58, 0x80008000, v58
    v_bfe_i32 v59, v101, 2, 1
    v_and_b32 v59, 0x80008000, v59
    v_bfe_i32 v60, v101, 3, 1
    v_and_b32 v60, 0x80008000, v60
    v_bfe_i32 v61, v101, 4, 1
    v_and_b32 v61, 0x80008000, v61
    v_lshlrev_b32 v100, 2, v100
    v_bfe_u32 v100, s28, v100, 3
    v_lshl_add_u32 v100, v55, 1, v100
    v_add_u32 v101, -5, v100
    v_min_u32 v100, v100, v101
    v_lshl_add_u32 v101, v100, 7, v18
    v_sub_u32 v102, 0x280, v101
    v_min_u32 v102, v102, v101
    v_mad_u32_u24 v52, v102, s26, v19
    v_add_u32 v101, 4, v100
    v_add_u32 v100, -1, v100
    v_min_u32 v100, v100, v101
    v_lshl_add_u32 v101, v100, 7, v18
    v_sub_u32 v102, 0x280, v101
    v_min_u32 v102, v102, v101
    v_mad_u32_u24 v53, v102, s26, v19
    v_add_u32 v101, 4, v100
    v_add_u32 v100, -1, v100
    v_min_u32 v100, v100, v101
    v_lshl_add_u32 v101, v100, 7, v18
    v_sub_u32 v102, 0x280, v101
    v_min_u32 v102, v102, v101
    v_mad_u32_u24 v54, v102, s26, v19
    v_mov_b32 v100, v97
    v_add_f32 v101, v100, v96
    v_add_f32 v102, v101, v96
    v_add_f32 v103, v102, v96
    v_add_f32 v104, v103, v96
    v_add_f32 v105, v104, v96
    v_add_f32 v106, v105, v96
    v_add_f32 v107, v106, v96
    v_cos_f32 v108, v100
    v_cos_f32 v109, v101
    v_cos_f32 v110, v102
    v_cos_f32 v111, v103
    v_cos_f32 v112, v104
    v_cos_f32 v113, v105
    v_cos_f32 v114, v106
    v_cos_f32 v115, v107
    v_cvt_pk_bf16_f32 v64, v108, v109
    v_cvt_pk_bf16_f32 v65, v110, v111
    v_cvt_pk_bf16_f32 v66, v112, v113
    v_cvt_pk_bf16_f32 v67, v114, v115
    v_sin_f32 v108, v100
    v_sin_f32 v109, v101
    v_sin_f32 v110, v102
    v_sin_f32 v111, v103
    v_sin_f32 v112, v104
    v_sin_f32 v113, v105
    v_sin_f32 v114, v106
    v_sin_f32 v115, v107
    v_cvt_pk_bf16_f32 v80, v108, v109
    v_cvt_pk_bf16_f32 v81, v110, v111
    v_cvt_pk_bf16_f32 v82, v112, v113
    v_cvt_pk_bf16_f32 v83, v114, v115
    buffer_load_ushort v132, v130, s[48:51], s64 offen offset:0
    buffer_load_ushort v136, v130, s[52:55], s64 offen offset:0
    buffer_load_ushort v133, v130, s[48:51], s65 offen offset:0
    v_add_f32 v100, v107, v98
    v_add_f32 v101, v100, v96
    v_add_f32 v102, v101, v96
    v_add_f32 v103, v102, v96
    v_add_f32 v104, v103, v96
    v_add_f32 v105, v104, v96
    v_add_f32 v106, v105, v96
    v_add_f32 v107, v106, v96
    v_cos_f32 v108, v100
    v_cos_f32 v109, v101
    v_cos_f32 v110, v102
    v_cos_f32 v111, v103
    v_cos_f32 v112, v104
    v_cos_f32 v113, v105
    v_cos_f32 v114, v106
    v_cos_f32 v115, v107
    v_cvt_pk_bf16_f32 v68, v108, v109
    v_cvt_pk_bf16_f32 v69, v110, v111
    v_cvt_pk_bf16_f32 v70, v112, v113
    v_cvt_pk_bf16_f32 v71, v114, v115
    v_sin_f32 v108, v100
    v_sin_f32 v109, v101
    v_sin_f32 v110, v102
    v_sin_f32 v111, v103
    v_sin_f32 v112, v104
    v_sin_f32 v113, v105
    v_sin_f32 v114, v106
    v_sin_f32 v115, v107
    v_cvt_pk_bf16_f32 v84, v108, v109
    v_cvt_pk_bf16_f32 v85, v110, v111
    v_cvt_pk_bf16_f32 v86, v112, v113
    v_cvt_pk_bf16_f32 v87, v114, v115
    buffer_load_ushort v137, v130, s[52:55], s65 offen offset:0
    buffer_load_ushort v134, v130, s[48:51], s66 offen offset:0
    buffer_load_ushort v138, v130, s[52:55], s66 offen offset:0
    v_add_f32 v100, v107, v98
    v_add_f32 v101, v100, v96
    v_add_f32 v102, v101, v96
    v_add_f32 v103, v102, v96
    v_add_f32 v104, v103, v96
    v_add_f32 v105, v104, v96
    v_add_f32 v106, v105, v96
    v_add_f32 v107, v106, v96
    v_cos_f32 v108, v100
    v_cos_f32 v109, v101
    v_cos_f32 v110, v102
    v_cos_f32 v111, v103
    v_cos_f32 v112, v104
    v_cos_f32 v113, v105
    v_cos_f32 v114, v106
    v_cos_f32 v115, v107
    v_cvt_pk_bf16_f32 v72, v108, v109
    v_cvt_pk_bf16_f32 v73, v110, v111
    v_cvt_pk_bf16_f32 v74, v112, v113
    v_cvt_pk_bf16_f32 v75, v114, v115
    v_sin_f32 v108, v100
    v_sin_f32 v109, v101
    v_sin_f32 v110, v102
    v_sin_f32 v111, v103
    v_sin_f32 v112, v104
    v_sin_f32 v113, v105
    v_sin_f32 v114, v106
    v_sin_f32 v115, v107
    v_cvt_pk_bf16_f32 v88, v108, v109
    v_cvt_pk_bf16_f32 v89, v110, v111
    v_cvt_pk_bf16_f32 v90, v112, v113
    v_cvt_pk_bf16_f32 v91, v114, v115
    buffer_load_ushort v135, v130, s[48:51], s67 offen offset:0
    buffer_load_ushort v139, v130, s[52:55], s67 offen offset:0
    buffer_load_ushort v140, v129, s[48:51], s64 offen offset:128
    v_add_f32 v100, v107, v98
    v_add_f32 v101, v100, v96
    v_add_f32 v102, v101, v96
    v_add_f32 v103, v102, v96
    v_add_f32 v104, v103, v96
    v_add_f32 v105, v104, v96
    v_add_f32 v106, v105, v96
    v_add_f32 v107, v106, v96
    v_cos_f32 v108, v100
    v_cos_f32 v109, v101
    v_cos_f32 v110, v102
    v_cos_f32 v111, v103
    v_cos_f32 v112, v104
    v_cos_f32 v113, v105
    v_cos_f32 v114, v106
    v_cos_f32 v115, v107
    v_cvt_pk_bf16_f32 v76, v108, v109
    v_cvt_pk_bf16_f32 v77, v110, v111
    v_cvt_pk_bf16_f32 v78, v112, v113
    v_cvt_pk_bf16_f32 v79, v114, v115
    v_sin_f32 v108, v100
    v_sin_f32 v109, v101
    v_sin_f32 v110, v102
    v_sin_f32 v111, v103
    v_sin_f32 v112, v104
    v_sin_f32 v113, v105
    v_sin_f32 v114, v106
    v_sin_f32 v115, v107
    v_cvt_pk_bf16_f32 v92, v108, v109
    v_cvt_pk_bf16_f32 v93, v110, v111
    v_cvt_pk_bf16_f32 v94, v112, v113
    v_cvt_pk_bf16_f32 v95, v114, v115
    buffer_load_ushort v144, v129, s[52:55], s64 offen offset:128
    buffer_load_ushort v141, v129, s[48:51], s65 offen offset:128
    buffer_load_ushort v145, v129, s[52:55], s65 offen offset:128
    s_cmp_lg_u32 s20, 0
    s_cbranch_scc1 K1_nosp1
    s_mov_b32 exec_lo, 0x00010001
    s_mov_b32 exec_hi, 0x00010001
    v_mov_b32 v80, 0xbf803f80
    v_mov_b32 v81, 0xbf803f80
    v_mov_b32 v82, 0xbf803f80
    v_mov_b32 v83, 0xbf803f80
    v_mov_b32 v84, 0xbf803f80
    v_mov_b32 v85, 0xbf803f80
    v_mov_b32 v86, 0xbf803f80
    v_mov_b32 v87, 0xbf803f80
    v_mov_b32 v88, 0xbf803f80
    v_mov_b32 v89, 0xbf803f80
    v_mov_b32 v90, 0xbf803f80
    v_mov_b32 v91, 0xbf803f80
    v_mov_b32 v92, 0xbf803f80
    v_mov_b32 v93, 0xbf803f80
    v_mov_b32 v94, 0xbf803f80
    v_mov_b32 v95, 0xbf803f80
    v_mul_u32_u24 v100, 2129920, v55
    v_add_u32 v100, 0, v100
    v_add_u32 v52, v100, v19
    v_mul_u32_u24 v100, 532480, v55
    v_add_u32 v100, 1064960, v100
    v_add_u32 v53, v100, v19
    v_mov_b32 v100, 0
    v_add_u32 v100, 532480, v100
    v_add_u32 v54, v100, v19
    v_mov_b32 v57, 0
    v_mov_b32 v58, 0
    v_mov_b32 v59, 0x80008000
    v_mov_b32 v60, 0
    v_mov_b32 v61, 0x80008000
    s_mov_b64 exec, -1
K1_nosp1:
    s_mov_b32 s40, 0x3e9e377a
    s_mov_b32 s42, 0xbf4f1bbd
    s_mov_b32 s44, 0x3f737871
    s_mov_b32 s46, 0x3f167918
    s_waitcnt vmcnt(14)
    buffer_load_ushort v142, v129, s[48:51], s66 offen offset:128
    buffer_load_ushort v146, v129, s[52:55], s66 offen offset:128
    buffer_load_ushort v143, v129, s[48:51], s67 offen offset:128
    buffer_load_ushort v147, v129, s[52:55], s67 offen offset:128
    s_mov_b32 exec_hi, 0
    buffer_load_ushort v148, v129, s[48:51], s64 offen offset:256
    s_mov_b32 exec_hi, -1
    s_mov_b32 exec_hi, 0
    buffer_load_ushort v152, v129, s[52:55], s64 offen offset:256
    s_mov_b32 exec_hi, -1
    s_mov_b32 exec_hi, 0
    buffer_load_ushort v149, v129, s[48:51], s65 offen offset:256
    s_mov_b32 exec_hi, -1
    s_mov_b32 exec_hi, 0
    buffer_load_ushort v153, v129, s[52:55], s65 offen offset:256
    s_mov_b32 exec_hi, -1
    s_mov_b32 exec_hi, 0
    buffer_load_ushort v150, v129, s[48:51], s66 offen offset:256
    s_mov_b32 exec_hi, -1
    s_mov_b32 exec_hi, 0
    buffer_load_ushort v154, v129, s[52:55], s66 offen offset:256
    s_mov_b32 exec_hi, -1
    s_mov_b32 exec_hi, 0
    buffer_load_ushort v151, v129, s[48:51], s67 offen offset:256
    s_mov_b32 exec_hi, -1
    s_mov_b32 exec_hi, 0
    buffer_load_ushort v155, v129, s[52:55], s67 offen offset:256
    s_mov_b32 exec_hi, -1
    v_lshlrev_b32 v20, 16, v2
    v_and_b32 v21, 0xffff0000, v2
    v_lshlrev_b32 v22, 16, v3
    v_and_b32 v23, 0xffff0000, v3
    v_lshlrev_b32 v24, 16, v4
    v_and_b32 v25, 0xffff0000, v4
    v_lshlrev_b32 v26, 16, v5
    v_and_b32 v27, 0xffff0000, v5
    v_lshlrev_b32 v28, 16, v6
    v_and_b32 v29, 0xffff0000, v6
    v_lshlrev_b32 v30, 16, v7
    v_and_b32 v31, 0xffff0000, v7
    v_lshlrev_b32 v32, 16, v8
    v_and_b32 v33, 0xffff0000, v8
    v_lshlrev_b32 v34, 16, v9
    v_and_b32 v35, 0xffff0000, v9
    v_lshlrev_b32 v36, 16, v10
    v_and_b32 v37, 0xffff0000, v10
    v_lshlrev_b32 v38, 16, v11
    v_and_b32 v39, 0xffff0000, v11
    v_pk_add_f32 v[116:117], v[20:21], v[22:23]
    v_pk_add_f32 v[118:119], v[24:25], v[26:27]
    v_pk_add_f32 v[116:117], v[116:117], v[28:29]
    v_pk_add_f32 v[118:119], v[118:119], v[30:31]
    v_pk_add_f32 v[116:117], v[116:117], v[32:33]
    v_pk_add_f32 v[118:119], v[118:119], v[34:35]
    v_pk_add_f32 v[116:117], v[116:117], v[36:37]
    v_pk_add_f32 v[118:119], v[118:119], v[38:39]
    v_pk_add_f32 v[116:117], v[116:117], v[118:119]
    v_add_f32 v18, v116, v117
    s_nop 1
    v_add_f32_dpp v18, v18, v18 quad_perm:[1,0,3,2] row_mask:0xf bank_mask:0xf
    s_nop 1
    v_add_f32_dpp v18, v18, v18 quad_perm:[2,3,0,1] row_mask:0xf bank_mask:0xf
    s_nop 1
    v_add_f32_dpp v18, v18, v18 row_half_mirror row_mask:0xf bank_mask:0xf
    s_nop 1
    v_add_f32_dpp v18, v18, v18 row_mirror row_mask:0xf bank_mask:0xf
    v_mov_b32 v118, v18
    s_nop 1
    v_permlane16_swap_b32 v18, v118
    v_add_f32 v18, v18, v118
    v_mul_f32 v18, 0x3acccccd, v18
    v_pk_add_f32 v[96:97], v[20:21], v[18:19] op_sel_hi:[1,0] neg_lo:[0,1] neg_hi:[0,1]
    v_pk_add_f32 v[98:99], v[22:23], v[18:19] op_sel_hi:[1,0] neg_lo:[0,1] neg_hi:[0,1]
    v_pk_add_f32 v[100:101], v[24:25], v[18:19] op_sel_hi:[1,0] neg_lo:[0,1] neg_hi:[0,1]
    v_pk_add_f32 v[102:103], v[26:27], v[18:19] op_sel_hi:[1,0] neg_lo:[0,1] neg_hi:[0,1]
    v_pk_add_f32 v[104:105], v[28:29], v[18:19] op_sel_hi:[1,0] neg_lo:[0,1] neg_hi:[0,1]
    v_pk_add_f32 v[106:107], v[30:31], v[18:19] op_sel_hi:[1,0] neg_lo:[0,1] neg_hi:[0,1]
    v_pk_add_f32 v[108:109], v[32:33], v[18:19] op_sel_hi:[1,0] neg_lo:[0,1] neg_hi:[0,1]
    v_pk_add_f32 v[110:111], v[34:35], v[18:19] op_sel_hi:[1,0] neg_lo:[0,1] neg_hi:[0,1]
    v_pk_add_f32 v[112:113], v[36:37], v[18:19] op_sel_hi:[1,0] neg_lo:[0,1] neg_hi:[0,1]
    v_pk_add_f32 v[114:115], v[38:39], v[18:19] op_sel_hi:[1,0] neg_lo:[0,1] neg_hi:[0,1]
    v_pk_mul_f32 v[116:117], v[96:97], v[96:97]
    v_pk_mul_f32 v[118:119], v[98:99], v[98:99]
    v_pk_fma_f32 v[116:117], v[100:101], v[100:101], v[116:117]
    v_pk_fma_f32 v[118:119], v[102:103], v[102:103], v[118:119]
    v_pk_fma_f32 v[116:117], v[104:105], v[104:105], v[116:117]
    v_pk_fma_f32 v[118:119], v[106:107], v[106:107], v[118:119]
    v_pk_fma_f32 v[116:117], v[108:109], v[108:109], v[116:117]
    v_pk_fma_f32 v[118:119], v[110:111], v[110:111], v[118:119]
    v_pk_fma_f32 v[116:117], v[112:113], v[112:113], v[116:117]
    v_pk_fma_f32 v[118:119], v[114:115], v[114:115], v[118:119]
    v_pk_add_f32 v[116:117], v[116:117], v[118:119]
    v_add_f32 v2, v116, v117
    s_nop 1
    v_add_f32_dpp v2, v2, v2 quad_perm:[1,0,3,2] row_mask:0xf bank_mask:0xf
    s_nop 1
    v_add_f32_dpp v2, v2, v2 quad_perm:[2,3,0,1] row_mask:0xf bank_mask:0xf
    s_nop 1
    v_add_f32_dpp v2, v2, v2 row_half_mirror row_mask:0xf bank_mask:0xf
    s_nop 1
    v_add_f32_dpp v2, v2, v2 row_mirror row_mask:0xf bank_mask:0xf
    v_mov_b32 v118, v2
    s_nop 1
    v_permlane16_swap_b32 v2, v118
    v_add_f32 v2, v2, v118
    v_mul_f32 v2, 0x3acccccd, v2
    v_cvt_pk_bf16_f32 v2, v2, v2
    v_lshlrev_b32 v2, 16, v2
    v_add_f32 v2, 0x3727c5ac, v2
    v_cvt_pk_bf16_f32 v2, v2, v2
    v_lshlrev_b32 v2, 16, v2
    v_sqrt_f32 v2, v2
    v_cvt_pk_bf16_f32 v18, v18, v18
    v_lshlrev_b32 v18, 16, v18
    v_cvt_pk_bf16_f32 v2, v2, v2
    v_lshlrev_b32 v2, 16, v2
    v_rcp_f32 v2, v2
    s_nop 0
    v_mul_f32 v4, v18, v2
    v_sub_f32 v4, 0, v4
    s_waitcnt vmcnt(24)
    v_and_b32 v41, 0xffff0000, v12
    v_lshlrev_b32 v42, 16, v13
    v_and_b32 v43, 0xffff0000, v13
    v_lshlrev_b32 v46, 16, v15
    v_and_b32 v47, 0xffff0000, v15
    v_and_b32 v51, 0xffff0000, v17
    v_pk_fma_f32 v[24:25], v[24:25], v[2:3], v[4:5] op_sel_hi:[1,0,0]
    v_pk_fma_f32 v[28:29], v[28:29], v[2:3], v[4:5] op_sel_hi:[1,0,0]
    v_pk_fma_f32 v[32:33], v[32:33], v[2:3], v[4:5] op_sel_hi:[1,0,0]
    v_pk_fma_f32 v[34:35], v[34:35], v[2:3], v[4:5] op_sel_hi:[1,0,0]
    v_pk_fma_f32 v[36:37], v[36:37], v[2:3], v[4:5] op_sel_hi:[1,0,0]
    v_pk_fma_f32 v[38:39], v[38:39], v[2:3], v[4:5] op_sel_hi:[1,0,0]
    v_pk_fma_f32 v[42:43], v[42:43], v[2:3], v[4:5] op_sel_hi:[1,0,0]
    v_pk_fma_f32 v[46:47], v[46:47], v[2:3], v[4:5] op_sel_hi:[1,0,0]
    v_fma_f32 v20, v20, v2, v4
    v_fma_f32 v30, v30, v2, v4
    v_fma_f32 v41, v41, v2, v4
    v_fma_f32 v51, v51, v2, v4
    v_cvt_pk_bf16_f32 v96, v20, v25
    v_cvt_pk_bf16_f32 v97, v30, v35
    ds_write_b64 v120, v[96:97] offset:0
    v_cvt_pk_bf16_f32 v98, v36, v41
    v_cvt_pk_bf16_f32 v99, v46, v51
    ds_write_b64 v121, v[98:99] offset:4096
    v_cvt_pk_bf16_f32 v100, v32, v37
    v_cvt_pk_bf16_f32 v101, v42, v47
    ds_write_b64 v122, v[100:101] offset:8192
    v_cvt_pk_bf16_f32 v102, v28, v33
    v_cvt_pk_bf16_f32 v103, v38, v43
    ds_write_b64 v123, v[102:103] offset:0
    v_cvt_pk_bf16_f32 v104, v24, v29
    v_cvt_pk_bf16_f32 v105, v34, v39
    ds_write_b64 v124, v[104:105] offset:4096
    s_waitcnt lgkmcnt(0)
    s_barrier
    ds_read_b128 v[4:7], v62 offset:0
    ds_read_b128 v[8:11], v63 offset:1024
    ds_read_b128 v[12:15], v125 offset:2048
    ds_read_b128 v[16:19], v126 offset:3072
    ds_read_b128 v[20:23], v62 offset:4096
    ds_read_b128 v[24:27], v63 offset:5120
    ds_read_b128 v[28:31], v125 offset:6144
    ds_read_b128 v[32:35], v126 offset:7168
    ds_read_b128 v[36:39], v62 offset:8192
    ds_read_b128 v[40:43], v63 offset:9216
    ds_read_b128 v[44:47], v125 offset:10240
    ds_read_b128 v[48:51], v126 offset:11264
    s_waitcnt lgkmcnt(11)
    v_mfma_f32_16x16x32_bf16 v[96:99], v[4:7], v[64:67], 0
    v_mfma_f32_16x16x32_bf16 v[100:103], v[4:7], v[80:83], 0
    s_waitcnt lgkmcnt(10)
    v_mfma_f32_16x16x32_bf16 v[96:99], v[8:11], v[68:71], v[96:99]
    v_mfma_f32_16x16x32_bf16 v[100:103], v[8:11], v[84:87], v[100:103]
    s_waitcnt lgkmcnt(9)
    v_mfma_f32_16x16x32_bf16 v[96:99], v[12:15], v[72:75], v[96:99]
    v_mfma_f32_16x16x32_bf16 v[100:103], v[12:15], v[88:91], v[100:103]
    s_waitcnt lgkmcnt(8)
    v_mfma_f32_16x16x32_bf16 v[96:99], v[16:19], v[76:79], v[96:99]
    v_mfma_f32_16x16x32_bf16 v[100:103], v[16:19], v[92:95], v[100:103]
    s_waitcnt lgkmcnt(7)
    v_mfma_f32_16x16x32_bf16 v[104:107], v[20:23], v[64:67], 0
    v_mfma_f32_16x16x32_bf16 v[108:111], v[20:23], v[80:83], 0
    s_waitcnt lgkmcnt(6)
    v_mfma_f32_16x16x32_bf16 v[104:107], v[24:27], v[68:71], v[104:107]
    v_mfma_f32_16x16x32_bf16 v[108:111], v[24:27], v[84:87], v[108:111]
    s_waitcnt lgkmcnt(5)
    v_mfma_f32_16x16x32_bf16 v[104:107], v[28:31], v[72:75], v[104:107]
    v_mfma_f32_16x16x32_bf16 v[108:111], v[28:31], v[88:91], v[108:111]
    s_waitcnt lgkmcnt(4)
    v_mfma_f32_16x16x32_bf16 v[104:107], v[32:35], v[76:79], v[104:107]
    v_mfma_f32_16x16x32_bf16 v[108:111], v[32:35], v[92:95], v[108:111]
    s_waitcnt lgkmcnt(3)
    v_mfma_f32_16x16x32_bf16 v[112:115], v[36:39], v[64:67], 0
    v_mfma_f32_16x16x32_bf16 v[116:119], v[36:39], v[80:83], 0
    s_waitcnt lgkmcnt(2)
    v_mfma_f32_16x16x32_bf16 v[112:115], v[40:43], v[68:71], v[112:115]
    v_mfma_f32_16x16x32_bf16 v[116:119], v[40:43], v[84:87], v[116:119]
    s_waitcnt lgkmcnt(1)
    v_mfma_f32_16x16x32_bf16 v[112:115], v[44:47], v[72:75], v[112:115]
    v_mfma_f32_16x16x32_bf16 v[116:119], v[44:47], v[88:91], v[116:119]
    s_waitcnt lgkmcnt(0)
    v_mfma_f32_16x16x32_bf16 v[112:115], v[48:51], v[76:79], v[112:115]
    v_mfma_f32_16x16x32_bf16 v[116:119], v[48:51], v[92:95], v[116:119]
    s_nop 6
    v_pk_add_f32 v[4:5], v[98:99], v[112:113]
    v_pk_add_f32 v[8:9], v[104:105], v[106:107]
    v_pk_add_f32 v[12:13], v[98:99], v[112:113] neg_lo:[0,1] neg_hi:[0,1]
    v_pk_add_f32 v[16:17], v[104:105], v[106:107] neg_lo:[0,1] neg_hi:[0,1]
    v_pk_add_f32 v[6:7], v[102:103], v[116:117]
    v_pk_add_f32 v[10:11], v[108:109], v[110:111]
    v_pk_add_f32 v[14:15], v[102:103], v[116:117] neg_lo:[0,1] neg_hi:[0,1]
    v_pk_add_f32 v[18:19], v[108:109], v[110:111] neg_lo:[0,1] neg_hi:[0,1]
    v_pk_fma_f32 v[20:21], v[4:5], s[40:41], v[96:97] op_sel_hi:[1,0,1]
    v_pk_fma_f32 v[24:25], v[4:5], s[42:43], v[96:97] op_sel_hi:[1,0,1]
    v_pk_mul_f32 v[28:29], v[12:13], s[44:45] op_sel_hi:[1,0]
    v_pk_mul_f32 v[32:33], v[12:13], s[46:47] op_sel_hi:[1,0]
    v_pk_add_f32 v[36:37], v[4:5], v[96:97]
    v_pk_fma_f32 v[22:23], v[6:7], s[40:41], v[100:101] op_sel_hi:[1,0,1]
    v_pk_fma_f32 v[26:27], v[6:7], s[42:43], v[100:101] op_sel_hi:[1,0,1]
    v_pk_mul_f32 v[30:31], v[14:15], s[44:45] op_sel_hi:[1,0]
    v_pk_mul_f32 v[34:35], v[14:15], s[46:47] op_sel_hi:[1,0]
    v_pk_add_f32 v[38:39], v[6:7], v[100:101]
    v_pk_fma_f32 v[20:21], v[8:9], s[42:43], v[20:21] op_sel_hi:[1,0,1]
    v_pk_fma_f32 v[24:25], v[8:9], s[40:41], v[24:25] op_sel_hi:[1,0,1]
    v_pk_fma_f32 v[28:29], v[16:17], s[46:47], v[28:29] op_sel_hi:[1,0,1]
    v_pk_fma_f32 v[32:33], v[16:17], s[44:45], v[32:33] op_sel_hi:[1,0,1] neg_lo:[1,0,0] neg_hi:[1,0,0]
    v_pk_add_f32 v[36:37], v[36:37], v[8:9]
    v_pk_fma_f32 v[22:23], v[10:11], s[42:43], v[22:23] op_sel_hi:[1,0,1]
    v_pk_fma_f32 v[26:27], v[10:11], s[40:41], v[26:27] op_sel_hi:[1,0,1]
    v_pk_fma_f32 v[30:31], v[18:19], s[46:47], v[30:31] op_sel_hi:[1,0,1]
    v_pk_fma_f32 v[34:35], v[18:19], s[44:45], v[34:35] op_sel_hi:[1,0,1] neg_lo:[1,0,0] neg_hi:[1,0,0]
    v_pk_add_f32 v[38:39], v[38:39], v[10:11]
    v_cvt_pk_bf16_f32 v40, v36, v37
    v_cvt_pk_bf16_f32 v41, v38, v39
    v_pk_add_f32 v[4:5], v[20:21], v[30:31]
    v_pk_add_f32 v[6:7], v[22:23], v[28:29] neg_lo:[0,1] neg_hi:[0,1]
    v_pk_add_f32 v[8:9], v[20:21], v[30:31] neg_lo:[0,1] neg_hi:[0,1]
    v_pk_add_f32 v[10:11], v[22:23], v[28:29]
    v_cvt_pk_bf16_f32 v42, v4, v5
    v_cvt_pk_bf16_f32 v43, v6, v7
    v_cvt_pk_bf16_f32 v48, v8, v9
    v_cvt_pk_bf16_f32 v49, v10, v11
    v_pk_add_f32 v[12:13], v[24:25], v[34:35]
    v_pk_add_f32 v[14:15], v[26:27], v[32:33] neg_lo:[0,1] neg_hi:[0,1]
    v_pk_add_f32 v[16:17], v[24:25], v[34:35] neg_lo:[0,1] neg_hi:[0,1]
    v_pk_add_f32 v[18:19], v[26:27], v[32:33]
    v_cvt_pk_bf16_f32 v44, v12, v13
    v_cvt_pk_bf16_f32 v45, v14, v15
    v_cvt_pk_bf16_f32 v46, v16, v17
    v_cvt_pk_bf16_f32 v47, v18, v19
    s_cmp_lg_u32 s20, 0
    s_cbranch_scc1 K1_nosp2
    s_mov_b32 exec_lo, 0x00010001
    s_mov_b32 exec_hi, 0x00010001
    v_mov_b32 v40, v41
    v_mov_b32 v41, 0
    v_cvt_pk_bf16_f32 v42, v20, v21
    v_cvt_pk_bf16_f32 v43, -v28, -v29
    v_cvt_pk_bf16_f32 v48, v22, v23
    v_cvt_pk_bf16_f32 v49, -v30, -v31
    v_cvt_pk_bf16_f32 v44, v24, v25
    v_cvt_pk_bf16_f32 v45, -v32, -v33
    v_cvt_pk_bf16_f32 v46, v26, v27
    v_cvt_pk_bf16_f32 v47, -v34, -v35
    s_mov_b64 exec, -1
K1_nosp2:
    v_xor_b32 v41, v41, v57
    v_xor_b32 v43, v43, v58
    v_xor_b32 v45, v45, v59
    v_xor_b32 v47, v47, v60
    v_xor_b32 v49, v49, v61
    v_permlane32_swap_b32 v40, v42
    v_permlane32_swap_b32 v41, v43
    v_permlane32_swap_b32 v44, v46
    v_permlane32_swap_b32 v45, v47
    v_permlane32_swap_b32 v48, v50
    v_permlane32_swap_b32 v49, v51
    v_permlane16_swap_b32 v40, v41
    v_permlane16_swap_b32 v42, v43
    v_permlane16_swap_b32 v44, v45
    v_permlane16_swap_b32 v46, v47
    v_permlane16_swap_b32 v48, v49
    v_permlane16_swap_b32 v50, v51
    s_waitcnt vmcnt(16)
    v_lshl_or_b32 v132, v136, 16, v132
    v_lshl_or_b32 v133, v137, 16, v133
    v_lshl_or_b32 v134, v138, 16, v134
    v_lshl_or_b32 v135, v139, 16, v135
    ds_write_b128 v157, v[132:135] offset:0
    s_waitcnt vmcnt(8)
    v_lshl_or_b32 v140, v144, 16, v140
    v_lshl_or_b32 v141, v145, 16, v141
    v_lshl_or_b32 v142, v146, 16, v142
    v_lshl_or_b32 v143, v147, 16, v143
    ds_write_b128 v157, v[140:143] offset:5120
    s_waitcnt vmcnt(0)
    v_lshl_or_b32 v148, v152, 16, v148
    v_lshl_or_b32 v149, v153, 16, v149
    v_lshl_or_b32 v150, v154, 16, v150
    v_lshl_or_b32 v151, v155, 16, v151
    s_mov_b32 exec_hi, 0
    ds_write_b128 v157, v[148:151] offset:10240
    s_mov_b32 exec_hi, -1
    buffer_store_dwordx4 v[40:43], v52, s[12:15], 0 offen
    buffer_store_dwordx4 v[44:47], v53, s[12:15], 0 offen
    s_mov_b32 exec_hi, 0
    buffer_store_dwordx4 v[48:51], v54, s[12:15], 0 offen
    s_mov_b32 exec_hi, -1
    s_waitcnt lgkmcnt(0)
    s_barrier
    ds_read_b128 v[132:135], v158 offset:0
    ds_read_b128 v[140:143], v158 offset:1280
    ds_read_b128 v[148:151], v158 offset:2560
    s_waitcnt lgkmcnt(2)
    buffer_store_dwordx4 v[132:135], v131, s[56:59], s62 offen
    s_waitcnt lgkmcnt(1)
    buffer_store_dwordx4 v[140:143], v131, s[56:59], s63 offen
    s_waitcnt lgkmcnt(0)
    s_mov_b32 exec_hi, 0
    buffer_store_dwordx4 v[148:151], v131, s[56:59], s68 offen
    s_mov_b32 exec_hi, -1
    s_lshl_b32 s69, s2, 2
    s_add_u32 s69, s69, s20
    s_cmp_ge_u32 s69, 104
    s_cbranch_scc1 K1_nofl
    s_add_u32 s32, s18, 9895936
    s_addc_u32 s33, s19, 0
    s_mov_b32 s34, 106496
    s_mov_b32 s35, 0x20000
    s_lshl_b32 s69, s69, 10
    v_lshlrev_b32 v156, 4, v1
    v_mov_b32 v160, 0
    v_mov_b32 v161, 0
    v_mov_b32 v162, 0
    v_mov_b32 v163, 0
    buffer_store_dwordx4 v[160:163], v156, s[32:35], s69 offen
K1_nofl:
K1_end:
    s_endpgm
.text
.globl kf_kernel
.p2align 8
.type kf_kernel,@function
kf_kernel:
    s_load_dwordx2 s[18:19], s[0:1], 80
    s_load_dwordx2 s[4:5], s[0:1], 0
    s_load_dwordx2 s[6:7], s[0:1], 40
    s_load_dwordx4 s[60:63], s[0:1], 56
    s_load_dwordx2 s[16:17], s[0:1], 32
    s_load_dwordx2 s[12:13], s[0:1], 48
    v_lshrrev_b32 v2, 6, v0
    v_and_b32 v1, 63, v0
    v_readfirstlane_b32 s20, v2
    s_cmp_ge_u32 s2, 256
    s_nop 2
    s_cbranch_scc1 KF_end
    v_lshlrev_b32 v0, 4, v1
    v_lshl_add_u32 v2, v1, 2, 0
    v_add_u32 v2, 159744, v2
    v_mov_b32 v3, 0
    ds_write_b32 v2, v3
    s_and_b32 s73, s2, 7
    s_lshl_b32 s73, s73, 5
    s_lshr_b32 s22, s2, 3
    s_add_u32 s73, s73, s22
    s_and_b32 s21, s2, 7
    s_lshr_b32 s23, s21, 2
    s_lshl_b32 s23, s23, 7
    s_and_b32 s21, s21, 3
    s_lshl_b32 s21, s21, 2
    s_add_u32 s23, s23, s21
    s_lshr_b32 s21, s22, 2
    s_lshl_b32 s21, s21, 4
    s_add_u32 s23, s23, s21
    s_and_b32 s21, s22, 3
    s_add_u32 s3, s23, s21
    s_and_b32 s21, s2, 7
    s_lshr_b32 s23, s21, 1
    s_lshl_b32 s23, s23, 6
    s_and_b32 s21, s21, 1
    s_lshl_b32 s21, s21, 2
    s_add_u32 s23, s23, s21
    s_lshr_b32 s21, s22, 2
    s_lshl_b32 s21, s21, 3
    s_add_u32 s23, s23, s21
    s_and_b32 s21, s22, 3
    s_add_u32 s98, s23, s21
    s_and_b32 s74, s3, 15
    s_mul_i32 s74, s74, 7
    s_min_u32 s74, s74, 101
    s_and_b32 s69, s98, 7
    s_lshl_b32 s69, s69, 2
    s_add_u32 s69, s69, s20
    s_mul_i32 s69, s69, 71680
    s_add_u32 s69, s69, 2211840
    s_lshr_b32 s27, s20, 1
    s_lshl_b32 s21, s27, 8
    s_add_u32 s21, s21, s2
    s_cmp_ge_u32 s21, 320
    s_cbranch_scc1 KF_idle
    s_mul_i32 s21, s21, 8320
    s_and_b32 s25, s20, 1
    s_lshl_b32 s22, s25, 12
    s_add_u32 s23, s21, s22
    s_xor_b32 s24, s22, 4096
    s_add_u32 s24, s24, s21
    v_lshlrev_b32 v2, 5, v1
    s_waitcnt lgkmcnt(0)
    s_mov_b32 s8, s18
    s_mov_b32 s9, s19
    s_mov_b32 s10, 2662400
    s_mov_b32 s11, 0x20000
    buffer_load_dwordx4 v[8:11], v2, s[8:11], s23 offen offset:0
    buffer_load_dwordx4 v[24:27], v2, s[8:11], s23 offen offset:16
    buffer_load_dwordx4 v[12:15], v2, s[8:11], s23 offen offset:2048
    buffer_load_dwordx4 v[28:31], v2, s[8:11], s23 offen offset:2064
    buffer_load_dwordx4 v[16:19], v2, s[8:11], s24 offen offset:0
    buffer_load_dwordx4 v[32:35], v2, s[8:11], s24 offen offset:16
    buffer_load_dwordx4 v[20:23], v2, s[8:11], s24 offen offset:2048
    buffer_load_dwordx4 v[36:39], v2, s[8:11], s24 offen offset:2064
    s_add_u32 s12, s18, 2686976
    s_addc_u32 s13, s19, 0
    s_mov_b32 s14, 2662400
    s_mov_b32 s15, 0x20000
    buffer_load_dwordx4 v[40:43], v0, s[12:15], s23 offen offset:0
    buffer_load_dwordx4 v[44:47], v0, s[12:15], s23 offen offset:1024
    buffer_load_dwordx4 v[48:51], v0, s[12:15], s23 offen offset:2048
    buffer_load_dwordx4 v[52:55], v0, s[12:15], s23 offen offset:3072
    s_add_u32 s28, s18, 10027008
    s_addc_u32 s29, s19, 0
    s_mov_b32 s30, 2662400
    s_mov_b32 s31, 0x20000
    s_add_u32 s56, s18, 5373952
    s_addc_u32 s57, s19, 0
    s_mov_b32 s58, 4505600
    s_mov_b32 s59, 0x20000
    s_add_u32 s64, s18, 9895936
    s_addc_u32 s65, s19, 0
    s_mov_b32 s66, 106496
    s_mov_b32 s67, 0x20000
    s_barrier
    v_and_b32 v4, 31, v1
    v_lshrrev_b32 v5, 5, v1
    s_lshl_b32 s25, s25, 5
    v_add_u32 v6, s25, v4
    v_cvt_f32_u32 v224, v6
    v_cvt_f32_u32 v225, v4
    v_lshl_add_u32 v7, v5, 2, s25
    v_cvt_f32_u32 v226, v7
    v_lshlrev_b32 v7, 2, v5
    v_cvt_f32_u32 v227, v7
    v_mul_f32 v228, 0x3c800000, v224
    v_mul_f32 v229, v226, v228
    v_add_f32 v249, v229, v228
    v_fma_f32 v250, 2.0, v228, v229
    v_fma_f32 v251, 2.0, v228, v249
    v_mul_f32 v231, 0x41000000, v228
    v_cos_f32 v240, v229
    v_cos_f32 v241, v249
    v_cos_f32 v242, v250
    v_cos_f32 v243, v251
    v_cos_f32 v230, v231
    v_sin_f32 v244, v229
    v_sin_f32 v245, v249
    v_sin_f32 v246, v250
    v_sin_f32 v247, v251
    v_sin_f32 v231, v231
    s_nop 0
    v_pk_mul_f32 v[248:249], v[240:241], v[230:231] op_sel_hi:[1,0]
    v_pk_mul_f32 v[252:253], v[244:245], v[230:231] op_sel_hi:[1,0]
    v_pk_mul_f32 v[250:251], v[242:243], v[230:231] op_sel_hi:[1,0]
    v_pk_mul_f32 v[254:255], v[246:247], v[230:231] op_sel_hi:[1,0]
    v_pk_fma_f32 v[248:249], v[244:245], v[230:231], v[248:249] op_sel:[0,1,0] op_sel_hi:[1,1,1] neg_lo:[1,0,0] neg_hi:[1,0,0]
    v_pk_fma_f32 v[252:253], v[240:241], v[230:231], v[252:253] op_sel:[0,1,0] op_sel_hi:[1,1,1]
    v_pk_fma_f32 v[250:251], v[246:247], v[230:231], v[250:251] op_sel:[0,1,0] op_sel_hi:[1,1,1] neg_lo:[1,0,0] neg_hi:[1,0,0]
    v_pk_fma_f32 v[254:255], v[242:243], v[230:231], v[254:255] op_sel:[0,1,0] op_sel_hi:[1,1,1]
    v_cvt_pk_bf16_f32 v56, v240, v241
    v_cvt_pk_bf16_f32 v72, v244, v245
    v_cvt_pk_bf16_f32 v57, v242, v243
    v_cvt_pk_bf16_f32 v73, v246, v247
    v_xor_b32 v88, 0x80008000, v72
    v_xor_b32 v89, 0x80008000, v73
    v_pk_mul_f32 v[240:241], v[248:249], v[230:231] op_sel_hi:[1,0]
    v_pk_mul_f32 v[244:245], v[252:253], v[230:231] op_sel_hi:[1,0]
    v_pk_mul_f32 v[242:243], v[250:251], v[230:231] op_sel_hi:[1,0]
    v_pk_mul_f32 v[246:247], v[254:255], v[230:231] op_sel_hi:[1,0]
    v_pk_fma_f32 v[240:241], v[252:253], v[230:231], v[240:241] op_sel:[0,1,0] op_sel_hi:[1,1,1] neg_lo:[1,0,0] neg_hi:[1,0,0]
    v_pk_fma_f32 v[244:245], v[248:249], v[230:231], v[244:245] op_sel:[0,1,0] op_sel_hi:[1,1,1]
    v_pk_fma_f32 v[242:243], v[254:255], v[230:231], v[242:243] op_sel:[0,1,0] op_sel_hi:[1,1,1] neg_lo:[1,0,0] neg_hi:[1,0,0]
    v_pk_fma_f32 v[246:247], v[250:251], v[230:231], v[246:247] op_sel:[0,1,0] op_sel_hi:[1,1,1]
    v_cvt_pk_bf16_f32 v58, v248, v249
    v_cvt_pk_bf16_f32 v74, v252, v253
    v_cvt_pk_bf16_f32 v59, v250, v251
    v_cvt_pk_bf16_f32 v75, v254, v255
    v_xor_b32 v90, 0x80008000, v74
    v_xor_b32 v91, 0x80008000, v75
    v_pk_mul_f32 v[248:249], v[240:241], v[230:231] op_sel_hi:[1,0]
    v_pk_mul_f32 v[252:253], v[244:245], v[230:231] op_sel_hi:[1,0]
    v_pk_mul_f32 v[250:251], v[242:243], v[230:231] op_sel_hi:[1,0]
    v_pk_mul_f32 v[254:255], v[246:247], v[230:231] op_sel_hi:[1,0]
    v_pk_fma_f32 v[248:249], v[244:245], v[230:231], v[248:249] op_sel:[0,1,0] op_sel_hi:[1,1,1] neg_lo:[1,0,0] neg_hi:[1,0,0]
    v_pk_fma_f32 v[252:253], v[240:241], v[230:231], v[252:253] op_sel:[0,1,0] op_sel_hi:[1,1,1]
    v_pk_fma_f32 v[250:251], v[246:247], v[230:231], v[250:251] op_sel:[0,1,0] op_sel_hi:[1,1,1] neg_lo:[1,0,0] neg_hi:[1,0,0]
    v_pk_fma_f32 v[254:255], v[242:243], v[230:231], v[254:255] op_sel:[0,1,0] op_sel_hi:[1,1,1]
    v_cvt_pk_bf16_f32 v60, v240, v241
    v_cvt_pk_bf16_f32 v76, v244, v245
    v_cvt_pk_bf16_f32 v61, v242, v243
    v_cvt_pk_bf16_f32 v77, v246, v247
    v_xor_b32 v92, 0x80008000, v76
    v_xor_b32 v93, 0x80008000, v77
    v_pk_mul_f32 v[240:241], v[248:249], v[230:231] op_sel_hi:[1,0]
    v_pk_mul_f32 v[244:245], v[252:253], v[230:231] op_sel_hi:[1,0]
    v_pk_mul_f32 v[242:243], v[250:251], v[230:231] op_sel_hi:[1,0]
    v_pk_mul_f32 v[246:247], v[254:255], v[230:231] op_sel_hi:[1,0]
    v_pk_fma_f32 v[240:241], v[252:253], v[230:231], v[240:241] op_sel:[0,1,0] op_sel_hi:[1,1,1] neg_lo:[1,0,0] neg_hi:[1,0,0]
    v_pk_fma_f32 v[244:245], v[248:249], v[230:231], v[244:245] op_sel:[0,1,0] op_sel_hi:[1,1,1]
    v_pk_fma_f32 v[242:243], v[254:255], v[230:231], v[242:243] op_sel:[0,1,0] op_sel_hi:[1,1,1] neg_lo:[1,0,0] neg_hi:[1,0,0]
    v_pk_fma_f32 v[246:247], v[250:251], v[230:231], v[246:247] op_sel:[0,1,0] op_sel_hi:[1,1,1]
    v_cvt_pk_bf16_f32 v62, v248, v249
    v_cvt_pk_bf16_f32 v78, v252, v253
    v_cvt_pk_bf16_f32 v63, v250, v251
    v_cvt_pk_bf16_f32 v79, v254, v255
    v_xor_b32 v94, 0x80008000, v78
    v_xor_b32 v95, 0x80008000, v79
    v_pk_mul_f32 v[248:249], v[240:241], v[230:231] op_sel_hi:[1,0]
    v_pk_mul_f32 v[252:253], v[244:245], v[230:231] op_sel_hi:[1,0]
    v_pk_mul_f32 v[250:251], v[242:243], v[230:231] op_sel_hi:[1,0]
    v_pk_mul_f32 v[254:255], v[246:247], v[230:231] op_sel_hi:[1,0]
    v_pk_fma_f32 v[248:249], v[244:245], v[230:231], v[248:249] op_sel:[0,1,0] op_sel_hi:[1,1,1] neg_lo:[1,0,0] neg_hi:[1,0,0]
    v_pk_fma_f32 v[252:253], v[240:241], v[230:231], v[252:253] op_sel:[0,1,0] op_sel_hi:[1,1,1]
    v_pk_fma_f32 v[250:251], v[246:247], v[230:231], v[250:251] op_sel:[0,1,0] op_sel_hi:[1,1,1] neg_lo:[1,0,0] neg_hi:[1,0,0]
    v_pk_fma_f32 v[254:255], v[242:243], v[230:231], v[254:255] op_sel:[0,1,0] op_sel_hi:[1,1,1]
    v_cvt_pk_bf16_f32 v64, v240, v241
    v_cvt_pk_bf16_f32 v80, v244, v245
    v_cvt_pk_bf16_f32 v65, v242, v243
    v_cvt_pk_bf16_f32 v81, v246, v247
    v_xor_b32 v96, 0x80008000, v80
    v_xor_b32 v97, 0x80008000, v81
    v_pk_mul_f32 v[240:241], v[248:249], v[230:231] op_sel_hi:[1,0]
    v_pk_mul_f32 v[244:245], v[252:253], v[230:231] op_sel_hi:[1,0]
    v_pk_mul_f32 v[242:243], v[250:251], v[230:231] op_sel_hi:[1,0]
    v_pk_mul_f32 v[246:247], v[254:255], v[230:231] op_sel_hi:[1,0]
    v_pk_fma_f32 v[240:241], v[252:253], v[230:231], v[240:241] op_sel:[0,1,0] op_sel_hi:[1,1,1] neg_lo:[1,0,0] neg_hi:[1,0,0]
    v_pk_fma_f32 v[244:245], v[248:249], v[230:231], v[244:245] op_sel:[0,1,0] op_sel_hi:[1,1,1]
    v_pk_fma_f32 v[242:243], v[254:255], v[230:231], v[242:243] op_sel:[0,1,0] op_sel_hi:[1,1,1] neg_lo:[1,0,0] neg_hi:[1,0,0]
    v_pk_fma_f32 v[246:247], v[250:251], v[230:231], v[246:247] op_sel:[0,1,0] op_sel_hi:[1,1,1]
    v_cvt_pk_bf16_f32 v66, v248, v249
    v_cvt_pk_bf16_f32 v82, v252, v253
    v_cvt_pk_bf16_f32 v67, v250, v251
    v_cvt_pk_bf16_f32 v83, v254, v255
    v_xor_b32 v98, 0x80008000, v82
    v_xor_b32 v99, 0x80008000, v83
    v_pk_mul_f32 v[248:249], v[240:241], v[230:231] op_sel_hi:[1,0]
    v_pk_mul_f32 v[252:253], v[244:245], v[230:231] op_sel_hi:[1,0]
    v_pk_mul_f32 v[250:251], v[242:243], v[230:231] op_sel_hi:[1,0]
    v_pk_mul_f32 v[254:255], v[246:247], v[230:231] op_sel_hi:[1,0]
    v_pk_fma_f32 v[248:249], v[244:245], v[230:231], v[248:249] op_sel:[0,1,0] op_sel_hi:[1,1,1] neg_lo:[1,0,0] neg_hi:[1,0,0]
    v_pk_fma_f32 v[252:253], v[240:241], v[230:231], v[252:253] op_sel:[0,1,0] op_sel_hi:[1,1,1]
    v_pk_fma_f32 v[250:251], v[246:247], v[230:231], v[250:251] op_sel:[0,1,0] op_sel_hi:[1,1,1] neg_lo:[1,0,0] neg_hi:[1,0,0]
    v_pk_fma_f32 v[254:255], v[242:243], v[230:231], v[254:255] op_sel:[0,1,0] op_sel_hi:[1,1,1]
    v_cvt_pk_bf16_f32 v68, v240, v241
    v_cvt_pk_bf16_f32 v84, v244, v245
    v_cvt_pk_bf16_f32 v69, v242, v243
    v_cvt_pk_bf16_f32 v85, v246, v247
    v_xor_b32 v100, 0x80008000, v84
    v_xor_b32 v101, 0x80008000, v85
    v_cvt_pk_bf16_f32 v70, v248, v249
    v_cvt_pk_bf16_f32 v86, v252, v253
    v_cvt_pk_bf16_f32 v71, v250, v251
    v_cvt_pk_bf16_f32 v87, v254, v255
    v_xor_b32 v102, 0x80008000, v86
    v_xor_b32 v103, 0x80008000, v87
    v_mul_f32 v228, 0x3a000000, v224
    v_mul_f32 v229, v227, v228
    v_add_f32 v241, v229, v228
    v_fma_f32 v242, 2.0, v228, v229
    v_fma_f32 v243, 2.0, v228, v241
    v_mul_f32 v231, 0x41000000, v228
    v_cos_f32 v128, v229
    v_cos_f32 v129, v241
    v_cos_f32 v130, v242
    v_cos_f32 v131, v243
    v_cos_f32 v230, v231
    v_sin_f32 v144, v229
    v_sin_f32 v145, v241
    v_sin_f32 v146, v242
    v_sin_f32 v147, v243
    v_sin_f32 v231, v231
    s_nop 0
    v_pk_mul_f32 v[132:133], v[128:129], v[230:231] op_sel_hi:[1,0]
    v_pk_mul_f32 v[148:149], v[144:145], v[230:231] op_sel_hi:[1,0]
    v_pk_mul_f32 v[134:135], v[130:131], v[230:231] op_sel_hi:[1,0]
    v_pk_mul_f32 v[150:151], v[146:147], v[230:231] op_sel_hi:[1,0]
    v_pk_fma_f32 v[132:133], v[144:145], v[230:231], v[132:133] op_sel:[0,1,0] op_sel_hi:[1,1,1] neg_lo:[1,0,0] neg_hi:[1,0,0]
    v_pk_fma_f32 v[148:149], v[128:129], v[230:231], v[148:149] op_sel:[0,1,0] op_sel_hi:[1,1,1]
    v_pk_fma_f32 v[134:135], v[146:147], v[230:231], v[134:135] op_sel:[0,1,0] op_sel_hi:[1,1,1] neg_lo:[1,0,0] neg_hi:[1,0,0]
    v_pk_fma_f32 v[150:151], v[130:131], v[230:231], v[150:151] op_sel:[0,1,0] op_sel_hi:[1,1,1]
    v_pk_mul_f32 v[136:137], v[132:133], v[230:231] op_sel_hi:[1,0]
    v_pk_mul_f32 v[152:153], v[148:149], v[230:231] op_sel_hi:[1,0]
    v_pk_mul_f32 v[138:139], v[134:135], v[230:231] op_sel_hi:[1,0]
    v_pk_mul_f32 v[154:155], v[150:151], v[230:231] op_sel_hi:[1,0]
    v_pk_fma_f32 v[136:137], v[148:149], v[230:231], v[136:137] op_sel:[0,1,0] op_sel_hi:[1,1,1] neg_lo:[1,0,0] neg_hi:[1,0,0]
    v_pk_fma_f32 v[152:153], v[132:133], v[230:231], v[152:153] op_sel:[0,1,0] op_sel_hi:[1,1,1]
    v_pk_fma_f32 v[138:139], v[150:151], v[230:231], v[138:139] op_sel:[0,1,0] op_sel_hi:[1,1,1] neg_lo:[1,0,0] neg_hi:[1,0,0]
    v_pk_fma_f32 v[154:155], v[134:135], v[230:231], v[154:155] op_sel:[0,1,0] op_sel_hi:[1,1,1]
    v_pk_mul_f32 v[140:141], v[136:137], v[230:231] op_sel_hi:[1,0]
    v_pk_mul_f32 v[156:157], v[152:153], v[230:231] op_sel_hi:[1,0]
    v_pk_mul_f32 v[142:143], v[138:139], v[230:231] op_sel_hi:[1,0]
    v_pk_mul_f32 v[158:159], v[154:155], v[230:231] op_sel_hi:[1,0]
    v_pk_fma_f32 v[140:141], v[152:153], v[230:231], v[140:141] op_sel:[0,1,0] op_sel_hi:[1,1,1] neg_lo:[1,0,0] neg_hi:[1,0,0]
    v_pk_fma_f32 v[156:157], v[136:137], v[230:231], v[156:157] op_sel:[0,1,0] op_sel_hi:[1,1,1]
    v_pk_fma_f32 v[142:143], v[154:155], v[230:231], v[142:143] op_sel:[0,1,0] op_sel_hi:[1,1,1] neg_lo:[1,0,0] neg_hi:[1,0,0]
    v_pk_fma_f32 v[158:159], v[138:139], v[230:231], v[158:159] op_sel:[0,1,0] op_sel_hi:[1,1,1]
    v_mul_f32 v6, 0x3a000000, v225
    v_mul_f32 v7, v226, v6
    s_mov_b32 s26, 0x35cccccd
    s_waitcnt vmcnt(10)
    v_mfma_f32_32x32x16_bf16 v[192:207], v[8:11], v[56:59], 0
    v_mul_f32 v228, 0x3d000000, v225
    v_mul_f32 v229, v227, v228
    v_add_f32 v249, v229, v228
    v_fma_f32 v250, 2.0, v228, v229
    v_fma_f32 v251, 2.0, v228, v249
    v_mul_f32 v231, 0x41000000, v228
    v_mfma_f32_32x32x16_bf16 v[208:223], v[24:27], v[56:59], 0
    v_cos_f32 v240, v229
    v_cos_f32 v241, v249
    v_mfma_f32_32x32x16_bf16 v[192:207], v[24:27], v[72:75], v[192:207]
    v_cos_f32 v242, v250
    v_cos_f32 v243, v251
    v_mfma_f32_32x32x16_bf16 v[208:223], v[8:11], v[88:91], v[208:223]
    v_cos_f32 v230, v231
    v_sin_f32 v244, v229
    s_waitcnt vmcnt(8)
    v_mfma_f32_32x32x16_bf16 v[192:207], v[12:15], v[60:63], v[192:207]
    v_sin_f32 v245, v249
    v_sin_f32 v246, v250
    v_mfma_f32_32x32x16_bf16 v[208:223], v[28:31], v[60:63], v[208:223]
    v_sin_f32 v247, v251
    v_sin_f32 v231, v231
    v_mfma_f32_32x32x16_bf16 v[192:207], v[28:31], v[76:79], v[192:207]
    v_add_f32 v233, v7, v6
    v_fma_f32 v234, 2.0, v6, v7
    v_fma_f32 v235, 2.0, v6, v233
    v_mul_f32 v3, 0x41000000, v6
    v_cos_f32 v160, v7
    v_mfma_f32_32x32x16_bf16 v[208:223], v[12:15], v[92:95], v[208:223]
    v_cos_f32 v161, v233
    v_cos_f32 v162, v234
    s_waitcnt vmcnt(6)
    v_mfma_f32_32x32x16_bf16 v[192:207], v[16:19], v[64:67], v[192:207]
    v_cos_f32 v163, v235
    v_cos_f32 v2, v3
    v_mfma_f32_32x32x16_bf16 v[208:223], v[32:35], v[64:67], v[208:223]
    v_sin_f32 v176, v7
    v_sin_f32 v177, v233
    v_mfma_f32_32x32x16_bf16 v[192:207], v[32:35], v[80:83], v[192:207]
    v_sin_f32 v178, v234
    v_sin_f32 v179, v235
    v_mfma_f32_32x32x16_bf16 v[208:223], v[16:19], v[96:99], v[208:223]
    v_sin_f32 v3, v3
    s_waitcnt vmcnt(4)
    v_mfma_f32_32x32x16_bf16 v[192:207], v[20:23], v[68:71], v[192:207]
    v_mfma_f32_32x32x16_bf16 v[208:223], v[36:39], v[68:71], v[208:223]
    v_mfma_f32_32x32x16_bf16 v[192:207], v[36:39], v[84:87], v[192:207]
    v_mfma_f32_32x32x16_bf16 v[208:223], v[20:23], v[100:103], v[208:223]
    v_pk_mul_f32 v[248:249], v[240:241], v[230:231] op_sel_hi:[1,0]
    v_pk_mul_f32 v[252:253], v[244:245], v[230:231] op_sel_hi:[1,0]
    v_pk_mul_f32 v[250:251], v[242:243], v[230:231] op_sel_hi:[1,0]
    v_pk_mul_f32 v[254:255], v[246:247], v[230:231] op_sel_hi:[1,0]
    v_pk_fma_f32 v[248:249], v[244:245], v[230:231], v[248:249] op_sel:[0,1,0] op_sel_hi:[1,1,1] neg_lo:[1,0,0] neg_hi:[1,0,0]
    v_pk_fma_f32 v[252:253], v[240:241], v[230:231], v[252:253] op_sel:[0,1,0] op_sel_hi:[1,1,1]
    v_pk_fma_f32 v[250:251], v[246:247], v[230:231], v[250:251] op_sel:[0,1,0] op_sel_hi:[1,1,1] neg_lo:[1,0,0] neg_hi:[1,0,0]
    v_pk_fma_f32 v[254:255], v[242:243], v[230:231], v[254:255] op_sel:[0,1,0] op_sel_hi:[1,1,1]
    v_cvt_pk_bf16_f32 v104, v240, v241
    v_cvt_pk_bf16_f32 v112, v244, v245
    v_cvt_pk_bf16_f32 v105, v242, v243
    v_cvt_pk_bf16_f32 v113, v246, v247
    v_xor_b32 v120, 0x80008000, v112
    v_xor_b32 v121, 0x80008000, v113
    v_pk_mul_f32 v[240:241], v[248:249], v[230:231] op_sel_hi:[1,0]
    v_pk_mul_f32 v[244:245], v[252:253], v[230:231] op_sel_hi:[1,0]
    v_pk_mul_f32 v[242:243], v[250:251], v[230:231] op_sel_hi:[1,0]
    v_pk_mul_f32 v[246:247], v[254:255], v[230:231] op_sel_hi:[1,0]
    v_pk_fma_f32 v[240:241], v[252:253], v[230:231], v[240:241] op_sel:[0,1,0] op_sel_hi:[1,1,1] neg_lo:[1,0,0] neg_hi:[1,0,0]
    v_pk_fma_f32 v[244:245], v[248:249], v[230:231], v[244:245] op_sel:[0,1,0] op_sel_hi:[1,1,1]
    v_pk_fma_f32 v[242:243], v[254:255], v[230:231], v[242:243] op_sel:[0,1,0] op_sel_hi:[1,1,1] neg_lo:[1,0,0] neg_hi:[1,0,0]
    v_pk_fma_f32 v[246:247], v[250:251], v[230:231], v[246:247] op_sel:[0,1,0] op_sel_hi:[1,1,1]
    v_cvt_pk_bf16_f32 v106, v248, v249
    v_cvt_pk_bf16_f32 v114, v252, v253
    v_cvt_pk_bf16_f32 v107, v250, v251
    v_cvt_pk_bf16_f32 v115, v254, v255
    v_xor_b32 v122, 0x80008000, v114
    v_xor_b32 v123, 0x80008000, v115
    v_pk_mul_f32 v[248:249], v[240:241], v[230:231] op_sel_hi:[1,0]
    v_pk_mul_f32 v[252:253], v[244:245], v[230:231] op_sel_hi:[1,0]
    v_pk_mul_f32 v[250:251], v[242:243], v[230:231] op_sel_hi:[1,0]
    v_pk_mul_f32 v[254:255], v[246:247], v[230:231] op_sel_hi:[1,0]
    v_pk_fma_f32 v[248:249], v[244:245], v[230:231], v[248:249] op_sel:[0,1,0] op_sel_hi:[1,1,1] neg_lo:[1,0,0] neg_hi:[1,0,0]
    v_pk_fma_f32 v[252:253], v[240:241], v[230:231], v[252:253] op_sel:[0,1,0] op_sel_hi:[1,1,1]
    v_pk_fma_f32 v[250:251], v[246:247], v[230:231], v[250:251] op_sel:[0,1,0] op_sel_hi:[1,1,1] neg_lo:[1,0,0] neg_hi:[1,0,0]
    v_pk_fma_f32 v[254:255], v[242:243], v[230:231], v[254:255] op_sel:[0,1,0] op_sel_hi:[1,1,1]
    v_cvt_pk_bf16_f32 v108, v240, v241
    v_cvt_pk_bf16_f32 v116, v244, v245
    v_cvt_pk_bf16_f32 v109, v242, v243
    v_cvt_pk_bf16_f32 v117, v246, v247
    v_xor_b32 v124, 0x80008000, v116
    v_xor_b32 v125, 0x80008000, v117
    v_cvt_pk_bf16_f32 v110, v248, v249
    v_cvt_pk_bf16_f32 v118, v252, v253
    v_cvt_pk_bf16_f32 v111, v250, v251
    v_cvt_pk_bf16_f32 v119, v254, v255
    v_xor_b32 v126, 0x80008000, v118
    v_xor_b32 v127, 0x80008000, v119
    v_pk_mul_f32 v[160:161], v[160:161], s[26:27] op_sel_hi:[1,0]
    v_pk_mul_f32 v[162:163], v[162:163], s[26:27] op_sel_hi:[1,0]
    v_pk_mul_f32 v[176:177], v[176:177], s[26:27] op_sel_hi:[1,0]
    v_pk_mul_f32 v[178:179], v[178:179], s[26:27] op_sel_hi:[1,0]
    v_pk_mul_f32 v[164:165], v[160:161], v[2:3] op_sel_hi:[1,0]
    v_pk_mul_f32 v[180:181], v[176:177], v[2:3] op_sel_hi:[1,0]
    v_pk_mul_f32 v[166:167], v[162:163], v[2:3] op_sel_hi:[1,0]
    v_pk_mul_f32 v[182:183], v[178:179], v[2:3] op_sel_hi:[1,0]
    v_pk_fma_f32 v[164:165], v[176:177], v[2:3], v[164:165] op_sel:[0,1,0] op_sel_hi:[1,1,1] neg_lo:[1,0,0] neg_hi:[1,0,0]
    v_pk_fma_f32 v[180:181], v[160:161], v[2:3], v[180:181] op_sel:[0,1,0] op_sel_hi:[1,1,1]
    v_pk_fma_f32 v[166:167], v[178:179], v[2:3], v[166:167] op_sel:[0,1,0] op_sel_hi:[1,1,1] neg_lo:[1,0,0] neg_hi:[1,0,0]
    v_pk_fma_f32 v[182:183], v[162:163], v[2:3], v[182:183] op_sel:[0,1,0] op_sel_hi:[1,1,1]
    v_pk_mul_f32 v[168:169], v[164:165], v[2:3] op_sel_hi:[1,0]
    v_pk_mul_f32 v[184:185], v[180:181], v[2:3] op_sel_hi:[1,0]
    v_pk_mul_f32 v[170:171], v[166:167], v[2:3] op_sel_hi:[1,0]
    v_pk_mul_f32 v[186:187], v[182:183], v[2:3] op_sel_hi:[1,0]
    v_pk_fma_f32 v[168:169], v[180:181], v[2:3], v[168:169] op_sel:[0,1,0] op_sel_hi:[1,1,1] neg_lo:[1,0,0] neg_hi:[1,0,0]
    v_pk_fma_f32 v[184:185], v[164:165], v[2:3], v[184:185] op_sel:[0,1,0] op_sel_hi:[1,1,1]
    v_pk_fma_f32 v[170:171], v[182:183], v[2:3], v[170:171] op_sel:[0,1,0] op_sel_hi:[1,1,1] neg_lo:[1,0,0] neg_hi:[1,0,0]
    v_pk_fma_f32 v[186:187], v[166:167], v[2:3], v[186:187] op_sel:[0,1,0] op_sel_hi:[1,1,1]
    v_pk_mul_f32 v[172:173], v[168:169], v[2:3] op_sel_hi:[1,0]
    v_pk_mul_f32 v[188:189], v[184:185], v[2:3] op_sel_hi:[1,0]
    v_pk_mul_f32 v[174:175], v[170:171], v[2:3] op_sel_hi:[1,0]
    v_pk_mul_f32 v[190:191], v[186:187], v[2:3] op_sel_hi:[1,0]
    v_pk_fma_f32 v[172:173], v[184:185], v[2:3], v[172:173] op_sel:[0,1,0] op_sel_hi:[1,1,1] neg_lo:[1,0,0] neg_hi:[1,0,0]
    v_pk_fma_f32 v[188:189], v[168:169], v[2:3], v[188:189] op_sel:[0,1,0] op_sel_hi:[1,1,1]
    v_pk_fma_f32 v[174:175], v[186:187], v[2:3], v[174:175] op_sel:[0,1,0] op_sel_hi:[1,1,1] neg_lo:[1,0,0] neg_hi:[1,0,0]
    v_pk_fma_f32 v[190:191], v[170:171], v[2:3], v[190:191] op_sel:[0,1,0] op_sel_hi:[1,1,1]
    v_pk_mul_f32 v[224:225], v[192:193], v[128:129]
    v_pk_mul_f32 v[240:241], v[208:209], v[128:129]
    v_pk_mul_f32 v[226:227], v[194:195], v[130:131]
    v_pk_mul_f32 v[242:243], v[210:211], v[130:131]
    v_pk_mul_f32 v[228:229], v[196:197], v[132:133]
    v_pk_mul_f32 v[244:245], v[212:213], v[132:133]
    v_pk_mul_f32 v[230:231], v[198:199], v[134:135]
    v_pk_mul_f32 v[246:247], v[214:215], v[134:135]
    v_pk_mul_f32 v[232:233], v[200:201], v[136:137]
    v_pk_mul_f32 v[248:249], v[216:217], v[136:137]
    v_pk_mul_f32 v[234:235], v[202:203], v[138:139]
    v_pk_mul_f32 v[250:251], v[218:219], v[138:139]
    v_pk_mul_f32 v[236:237], v[204:205], v[140:141]
    v_pk_mul_f32 v[252:253], v[220:221], v[140:141]
    v_pk_mul_f32 v[238:239], v[206:207], v[142:143]
    v_pk_mul_f32 v[254:255], v[222:223], v[142:143]
    v_pk_fma_f32 v[224:225], v[208:209], v[144:145], v[224:225]
    v_pk_fma_f32 v[240:241], v[192:193], v[144:145], v[240:241] neg_lo:[1,0,0] neg_hi:[1,0,0]
    v_pk_fma_f32 v[226:227], v[210:211], v[146:147], v[226:227]
    v_pk_fma_f32 v[242:243], v[194:195], v[146:147], v[242:243] neg_lo:[1,0,0] neg_hi:[1,0,0]
    v_pk_fma_f32 v[228:229], v[212:213], v[148:149], v[228:229]
    v_pk_fma_f32 v[244:245], v[196:197], v[148:149], v[244:245] neg_lo:[1,0,0] neg_hi:[1,0,0]
    v_pk_fma_f32 v[230:231], v[214:215], v[150:151], v[230:231]
    v_pk_fma_f32 v[246:247], v[198:199], v[150:151], v[246:247] neg_lo:[1,0,0] neg_hi:[1,0,0]
    v_pk_fma_f32 v[232:233], v[216:217], v[152:153], v[232:233]
    v_pk_fma_f32 v[248:249], v[200:201], v[152:153], v[248:249] neg_lo:[1,0,0] neg_hi:[1,0,0]
    v_pk_fma_f32 v[234:235], v[218:219], v[154:155], v[234:235]
    v_pk_fma_f32 v[250:251], v[202:203], v[154:155], v[250:251] neg_lo:[1,0,0] neg_hi:[1,0,0]
    v_pk_fma_f32 v[236:237], v[220:221], v[156:157], v[236:237]
    v_pk_fma_f32 v[252:253], v[204:205], v[156:157], v[252:253] neg_lo:[1,0,0] neg_hi:[1,0,0]
    v_pk_fma_f32 v[238:239], v[222:223], v[158:159], v[238:239]
    v_pk_fma_f32 v[254:255], v[206:207], v[158:159], v[254:255] neg_lo:[1,0,0] neg_hi:[1,0,0]
    v_cvt_pk_bf16_f32 v8, v224, v225
    v_cvt_pk_bf16_f32 v9, v226, v227
    v_cvt_pk_bf16_f32 v10, v228, v229
    v_cvt_pk_bf16_f32 v11, v230, v231
    v_cvt_pk_bf16_f32 v12, v232, v233
    v_cvt_pk_bf16_f32 v13, v234, v235
    v_cvt_pk_bf16_f32 v14, v236, v237
    v_cvt_pk_bf16_f32 v15, v238, v239
    v_cvt_pk_bf16_f32 v16, v240, v241
    v_cvt_pk_bf16_f32 v17, v242, v243
    v_cvt_pk_bf16_f32 v18, v244, v245
    v_cvt_pk_bf16_f32 v19, v246, v247
    v_cvt_pk_bf16_f32 v20, v248, v249
    v_cvt_pk_bf16_f32 v21, v250, v251
    v_cvt_pk_bf16_f32 v22, v252, v253
    v_cvt_pk_bf16_f32 v23, v254, v255
    v_mfma_f32_32x32x16_bf16 v[192:207], v[104:107], v[8:11], 0
    v_mfma_f32_32x32x16_bf16 v[208:223], v[104:107], v[16:19], 0
    v_mfma_f32_32x32x16_bf16 v[192:207], v[112:115], v[16:19], v[192:207]
    v_mfma_f32_32x32x16_bf16 v[208:223], v[120:123], v[8:11], v[208:223]
    v_mfma_f32_32x32x16_bf16 v[192:207], v[108:111], v[12:15], v[192:207]
    s_waitcnt vmcnt(0)
    v_mfma_f32_32x32x16_bf16 v[208:223], v[108:111], v[20:23], v[208:223]
    v_lshlrev_b32 v128, 16, v40
    v_and_b32 v144, 0xffff0000, v40
    v_lshlrev_b32 v129, 16, v41
    v_and_b32 v145, 0xffff0000, v41
    v_lshlrev_b32 v130, 16, v42
    v_and_b32 v146, 0xffff0000, v42
    v_mfma_f32_32x32x16_bf16 v[192:207], v[116:119], v[20:23], v[192:207]
    v_lshlrev_b32 v131, 16, v43
    v_and_b32 v147, 0xffff0000, v43
    v_lshlrev_b32 v132, 16, v44
    v_and_b32 v148, 0xffff0000, v44
    v_lshlrev_b32 v133, 16, v45
    v_and_b32 v149, 0xffff0000, v45
    v_mfma_f32_32x32x16_bf16 v[208:223], v[124:127], v[12:15], v[208:223]
    v_lshlrev_b32 v134, 16, v46
    v_and_b32 v150, 0xffff0000, v46
    v_lshlrev_b32 v135, 16, v47
    v_and_b32 v151, 0xffff0000, v47
    v_lshlrev_b32 v136, 16, v48
    v_and_b32 v152, 0xffff0000, v48
    v_lshlrev_b32 v137, 16, v49
    v_and_b32 v153, 0xffff0000, v49
    v_lshlrev_b32 v138, 16, v50
    v_and_b32 v154, 0xffff0000, v50
    v_lshlrev_b32 v139, 16, v51
    v_and_b32 v155, 0xffff0000, v51
    v_lshlrev_b32 v140, 16, v52
    v_and_b32 v156, 0xffff0000, v52
    v_lshlrev_b32 v141, 16, v53
    v_and_b32 v157, 0xffff0000, v53
    v_lshlrev_b32 v142, 16, v54
    v_and_b32 v158, 0xffff0000, v54
    v_lshlrev_b32 v143, 16, v55
    v_and_b32 v159, 0xffff0000, v55
    v_pk_mul_f32 v[224:225], v[192:193], v[128:129]
    v_pk_mul_f32 v[240:241], v[208:209], v[128:129]
    v_pk_mul_f32 v[226:227], v[194:195], v[130:131]
    v_pk_mul_f32 v[242:243], v[210:211], v[130:131]
    v_pk_mul_f32 v[228:229], v[196:197], v[132:133]
    v_pk_mul_f32 v[244:245], v[212:213], v[132:133]
    v_pk_mul_f32 v[230:231], v[198:199], v[134:135]
    v_pk_mul_f32 v[246:247], v[214:215], v[134:135]
    v_pk_mul_f32 v[232:233], v[200:201], v[136:137]
    v_pk_mul_f32 v[248:249], v[216:217], v[136:137]
    v_pk_mul_f32 v[234:235], v[202:203], v[138:139]
    v_pk_mul_f32 v[250:251], v[218:219], v[138:139]
    v_pk_mul_f32 v[236:237], v[204:205], v[140:141]
    v_pk_mul_f32 v[252:253], v[220:221], v[140:141]
    v_pk_mul_f32 v[238:239], v[206:207], v[142:143]
    v_pk_mul_f32 v[254:255], v[222:223], v[142:143]
    v_pk_fma_f32 v[224:225], v[208:209], v[144:145], v[224:225] neg_lo:[1,0,0] neg_hi:[1,0,0]
    v_pk_fma_f32 v[240:241], v[192:193], v[144:145], v[240:241]
    v_pk_fma_f32 v[226:227], v[210:211], v[146:147], v[226:227] neg_lo:[1,0,0] neg_hi:[1,0,0]
    v_pk_fma_f32 v[242:243], v[194:195], v[146:147], v[242:243]
    v_pk_fma_f32 v[228:229], v[212:213], v[148:149], v[228:229] neg_lo:[1,0,0] neg_hi:[1,0,0]
    v_pk_fma_f32 v[244:245], v[196:197], v[148:149], v[244:245]
    v_pk_fma_f32 v[230:231], v[214:215], v[150:151], v[230:231] neg_lo:[1,0,0] neg_hi:[1,0,0]
    v_pk_fma_f32 v[246:247], v[198:199], v[150:151], v[246:247]
    v_pk_fma_f32 v[232:233], v[216:217], v[152:153], v[232:233] neg_lo:[1,0,0] neg_hi:[1,0,0]
    v_pk_fma_f32 v[248:249], v[200:201], v[152:153], v[248:249]
    v_pk_fma_f32 v[234:235], v[218:219], v[154:155], v[234:235] neg_lo:[1,0,0] neg_hi:[1,0,0]
    v_pk_fma_f32 v[250:251], v[202:203], v[154:155], v[250:251]
    v_pk_fma_f32 v[236:237], v[220:221], v[156:157], v[236:237] neg_lo:[1,0,0] neg_hi:[1,0,0]
    v_pk_fma_f32 v[252:253], v[204:205], v[156:157], v[252:253]
    v_pk_fma_f32 v[238:239], v[222:223], v[158:159], v[238:239] neg_lo:[1,0,0] neg_hi:[1,0,0]
    v_pk_fma_f32 v[254:255], v[206:207], v[158:159], v[254:255]
    v_cvt_pk_bf16_f32 v8, v224, v225
    v_cvt_pk_bf16_f32 v9, v226, v227
    v_cvt_pk_bf16_f32 v10, v228, v229
    v_cvt_pk_bf16_f32 v11, v230, v231
    v_cvt_pk_bf16_f32 v12, v232, v233
    v_cvt_pk_bf16_f32 v13, v234, v235
    v_cvt_pk_bf16_f32 v14, v236, v237
    v_cvt_pk_bf16_f32 v15, v238, v239
    v_cvt_pk_bf16_f32 v16, v240, v241
    v_cvt_pk_bf16_f32 v17, v242, v243
    v_cvt_pk_bf16_f32 v18, v244, v245
    v_cvt_pk_bf16_f32 v19, v246, v247
    v_cvt_pk_bf16_f32 v20, v248, v249
    v_cvt_pk_bf16_f32 v21, v250, v251
    v_cvt_pk_bf16_f32 v22, v252, v253
    v_cvt_pk_bf16_f32 v23, v254, v255
    v_mfma_f32_32x32x16_bf16 v[192:207], v[8:11], v[104:107], 0
    v_mfma_f32_32x32x16_bf16 v[208:223], v[16:19], v[104:107], 0
    v_mfma_f32_32x32x16_bf16 v[192:207], v[16:19], v[120:123], v[192:207]
    v_mfma_f32_32x32x16_bf16 v[208:223], v[8:11], v[112:115], v[208:223]
    v_mfma_f32_32x32x16_bf16 v[192:207], v[12:15], v[108:111], v[192:207]
    v_mfma_f32_32x32x16_bf16 v[208:223], v[20:23], v[108:111], v[208:223]
    v_mfma_f32_32x32x16_bf16 v[192:207], v[20:23], v[124:127], v[192:207]
    v_mfma_f32_32x32x16_bf16 v[208:223], v[12:15], v[116:119], v[208:223]
    s_lshl_b32 s24, s20, 12
    s_add_u32 s24, s24, 143360
    v_add_u32 v4, s24, v0
    s_xor_b32 s24, s20, 1
    s_lshl_b32 s24, s24, 12
    s_add_u32 s24, s24, 143360
    v_add_u32 v5, s24, v0
    v_and_b32 v2, 31, v1
    v_lshrrev_b32 v7, 5, v1
    v_xor_b32 v7, v7, v1
    v_and_b32 v7, 7, v7
    v_lshlrev_b32 v7, 4, v7
    v_lshl_add_u32 v6, v2, 7, v7
    v_add_u32 v6, s24, v6
    v_lshrrev_b32 v2, 3, v1
    v_xor_b32 v7, v2, v1
    v_and_b32 v7, 7, v7
    v_lshlrev_b32 v7, 4, v7
    v_lshl_add_u32 v7, v2, 7, v7
    v_add_u32 v7, s24, v7
    v_pk_mul_f32 v[224:225], v[192:193], v[160:161]
    v_pk_mul_f32 v[240:241], v[208:209], v[160:161]
    v_pk_mul_f32 v[226:227], v[194:195], v[162:163]
    v_pk_mul_f32 v[242:243], v[210:211], v[162:163]
    v_pk_mul_f32 v[228:229], v[196:197], v[164:165]
    v_pk_mul_f32 v[244:245], v[212:213], v[164:165]
    v_pk_mul_f32 v[230:231], v[198:199], v[166:167]
    v_pk_mul_f32 v[246:247], v[214:215], v[166:167]
    v_pk_mul_f32 v[232:233], v[200:201], v[168:169]
    v_pk_mul_f32 v[248:249], v[216:217], v[168:169]
    v_pk_mul_f32 v[234:235], v[202:203], v[170:171]
    v_pk_mul_f32 v[250:251], v[218:219], v[170:171]
    v_pk_mul_f32 v[236:237], v[204:205], v[172:173]
    v_pk_mul_f32 v[252:253], v[220:221], v[172:173]
    v_pk_mul_f32 v[238:239], v[206:207], v[174:175]
    v_pk_mul_f32 v[254:255], v[222:223], v[174:175]
    v_pk_fma_f32 v[224:225], v[208:209], v[176:177], v[224:225] neg_lo:[1,0,0] neg_hi:[1,0,0]
    v_pk_fma_f32 v[240:241], v[192:193], v[176:177], v[240:241]
    v_pk_fma_f32 v[226:227], v[210:211], v[178:179], v[226:227] neg_lo:[1,0,0] neg_hi:[1,0,0]
    v_pk_fma_f32 v[242:243], v[194:195], v[178:179], v[242:243]
    v_pk_fma_f32 v[228:229], v[212:213], v[180:181], v[228:229] neg_lo:[1,0,0] neg_hi:[1,0,0]
    v_pk_fma_f32 v[244:245], v[196:197], v[180:181], v[244:245]
    v_pk_fma_f32 v[230:231], v[214:215], v[182:183], v[230:231] neg_lo:[1,0,0] neg_hi:[1,0,0]
    v_pk_fma_f32 v[246:247], v[198:199], v[182:183], v[246:247]
    v_pk_fma_f32 v[232:233], v[216:217], v[184:185], v[232:233] neg_lo:[1,0,0] neg_hi:[1,0,0]
    v_pk_fma_f32 v[248:249], v[200:201], v[184:185], v[248:249]
    v_pk_fma_f32 v[234:235], v[218:219], v[186:187], v[234:235] neg_lo:[1,0,0] neg_hi:[1,0,0]
    v_pk_fma_f32 v[250:251], v[202:203], v[186:187], v[250:251]
    v_pk_fma_f32 v[236:237], v[220:221], v[188:189], v[236:237] neg_lo:[1,0,0] neg_hi:[1,0,0]
    v_pk_fma_f32 v[252:253], v[204:205], v[188:189], v[252:253]
    v_pk_fma_f32 v[238:239], v[222:223], v[190:191], v[238:239] neg_lo:[1,0,0] neg_hi:[1,0,0]
    v_pk_fma_f32 v[254:255], v[206:207], v[190:191], v[254:255]
    v_cvt_pk_bf16_f32 v8, v224, v225
    v_cvt_pk_bf16_f32 v9, v226, v227
    v_cvt_pk_bf16_f32 v10, v228, v229
    v_cvt_pk_bf16_f32 v11, v230, v231
    v_cvt_pk_bf16_f32 v12, v232, v233
    v_cvt_pk_bf16_f32 v13, v234, v235
    v_cvt_pk_bf16_f32 v14, v236, v237
    v_cvt_pk_bf16_f32 v15, v238, v239
    v_cvt_pk_bf16_f32 v16, v240, v241
    v_cvt_pk_bf16_f32 v17, v242, v243
    v_cvt_pk_bf16_f32 v18, v244, v245
    v_cvt_pk_bf16_f32 v19, v246, v247
    v_cvt_pk_bf16_f32 v20, v248, v249
    v_cvt_pk_bf16_f32 v21, v250, v251
    v_cvt_pk_bf16_f32 v22, v252, v253
    v_cvt_pk_bf16_f32 v23, v254, v255
    ds_write_b128 v4, v[8:11] offset:0
    ds_write_b128 v4, v[12:15] offset:1024
    ds_write_b128 v4, v[16:19] offset:2048
    ds_write_b128 v4, v[20:23] offset:3072
    s_lshl_b32 s26, s20, 2
    s_add_u32 s26, s26, 159760
    v_mov_b32 v2, s26
    v_mov_b32 v3, 1
    v_xor_b32 v4, 4, v2
    ds_write_b32 v2, v3
    v_mfma_f32_32x32x16_bf16 v[192:207], v[8:11], v[56:59], 0
    v_mfma_f32_32x32x16_bf16 v[208:223], v[16:19], v[56:59], 0
    v_mfma_f32_32x32x16_bf16 v[192:207], v[16:19], v[88:91], v[192:207]
    v_mfma_f32_32x32x16_bf16 v[208:223], v[8:11], v[72:75], v[208:223]
    s_mov_b32 s72, 32768
KF_xs:
    ds_read_b32 v3, v4
    s_waitcnt lgkmcnt(0)
    v_cmp_eq_u32 vcc, 0, v3
    s_sub_u32 s72, s72, 1
    s_nop 5
    s_cbranch_scc1 KF_xsd
    s_cbranch_vccnz KF_xs
KF_xsd:
    ds_read_b128 v[24:27], v5 offset:0
    ds_read_b128 v[28:31], v5 offset:1024
    ds_read_b128 v[32:35], v5 offset:2048
    ds_read_b128 v[36:39], v5 offset:3072
    v_mfma_f32_32x32x16_bf16 v[192:207], v[12:15], v[60:63], v[192:207]
    v_mfma_f32_32x32x16_bf16 v[208:223], v[20:23], v[60:63], v[208:223]
    v_mfma_f32_32x32x16_bf16 v[192:207], v[20:23], v[92:95], v[192:207]
    v_mfma_f32_32x32x16_bf16 v[208:223], v[12:15], v[76:79], v[208:223]
    s_waitcnt lgkmcnt(0)
    v_mfma_f32_32x32x16_bf16 v[192:207], v[24:27], v[64:67], v[192:207]
    v_mfma_f32_32x32x16_bf16 v[208:223], v[32:35], v[64:67], v[208:223]
    v_mfma_f32_32x32x16_bf16 v[192:207], v[32:35], v[96:99], v[192:207]
    v_mfma_f32_32x32x16_bf16 v[208:223], v[24:27], v[80:83], v[208:223]
    v_mfma_f32_32x32x16_bf16 v[192:207], v[28:31], v[68:71], v[192:207]
    v_mfma_f32_32x32x16_bf16 v[208:223], v[36:39], v[68:71], v[208:223]
    v_mfma_f32_32x32x16_bf16 v[192:207], v[36:39], v[100:103], v[192:207]
    v_mfma_f32_32x32x16_bf16 v[208:223], v[28:31], v[84:87], v[208:223]
    s_nop 10
    v_cvt_pk_bf16_f32 v224, v192, v193
    v_cvt_pk_bf16_f32 v225, v194, v195
    v_cvt_pk_bf16_f32 v226, v208, v209
    v_cvt_pk_bf16_f32 v227, v210, v211
    v_cvt_pk_bf16_f32 v228, v196, v197
    v_cvt_pk_bf16_f32 v229, v198, v199
    v_cvt_pk_bf16_f32 v230, v212, v213
    v_cvt_pk_bf16_f32 v231, v214, v215
    v_cvt_pk_bf16_f32 v232, v200, v201
    v_cvt_pk_bf16_f32 v233, v202, v203
    v_cvt_pk_bf16_f32 v234, v216, v217
    v_cvt_pk_bf16_f32 v235, v218, v219
    v_cvt_pk_bf16_f32 v236, v204, v205
    v_cvt_pk_bf16_f32 v237, v206, v207
    v_cvt_pk_bf16_f32 v238, v220, v221
    v_cvt_pk_bf16_f32 v239, v222, v223
    v_permlane32_swap_b32 v224, v226
    v_permlane32_swap_b32 v225, v227
    ds_write_b128 v6, v[224:227]
    v_permlane32_swap_b32 v228, v230
    v_permlane32_swap_b32 v229, v231
    v_xor_b32 v2, 32, v6
    ds_write_b128 v2, v[228:231]
    v_permlane32_swap_b32 v232, v234
    v_permlane32_swap_b32 v233, v235
    v_xor_b32 v2, 64, v6
    ds_write_b128 v2, v[232:235]
    v_permlane32_swap_b32 v236, v238
    v_permlane32_swap_b32 v237, v239
    v_xor_b32 v2, 96, v6
    ds_write_b128 v2, v[236:239]
    s_waitcnt lgkmcnt(0)
    ds_read_b128 v[8:11], v7 offset:0
    ds_read_b128 v[12:15], v7 offset:1024
    ds_read_b128 v[16:19], v7 offset:2048
    ds_read_b128 v[20:23], v7 offset:3072
    s_waitcnt lgkmcnt(3)
    buffer_store_dwordx4 v[8:11], v0, s[28:31], s23 offen offset:0 sc1
    s_waitcnt lgkmcnt(2)
    buffer_store_dwordx4 v[12:15], v0, s[28:31], s23 offen offset:1024 sc1
    s_waitcnt lgkmcnt(1)
    buffer_store_dwordx4 v[16:19], v0, s[28:31], s23 offen offset:2048 sc1
    s_waitcnt lgkmcnt(0)
    buffer_store_dwordx4 v[20:23], v0, s[28:31], s23 offen offset:3072 sc1
    s_nop 0
    s_branch KF_k2done
KF_idle:
    s_lshl_b32 s55, s2, 1
    s_add_u32 s55, s55, s20
    s_sub_u32 s55, s55, 130
    s_mul_i32 s28, s20, 12288
    v_lshrrev_b32 v5, 3, v1
    v_and_b32 v6, 7, v1
    v_xor_b32 v6, v6, v5
    v_lshlrev_b32 v6, 4, v6
    v_mul_u32_u24 v4, 3456, v5
    v_add_u32 v4, v4, v6
    v_mul_u32_u24 v5, 0x500, v5
    v_add_u32 v5, v5, v6
    s_mul_i32 s21, s55, 2428
    s_lshr_b32 s21, s21, 16
    s_mul_i32 s22, s21, 27
    s_sub_u32 s22, s55, s22
    s_mul_i32 s30, s21, 110592
    s_lshl_b32 s23, s22, 7
    s_add_u32 s30, s30, s23
    s_add_u32 s31, s30, 55296
    s_mul_i32 s40, s22, 81920
    s_lshl_b32 s23, s21, 10
    s_add_u32 s40, s40, s23
    s_add_u32 s41, s40, 20480
    s_add_u32 s42, s41, 20480
    s_add_u32 s43, s42, 20480
    s_mov_b32 s44, 0
    s_waitcnt lgkmcnt(0)
    s_barrier
    s_mov_b32 s36, s16
    s_mov_b32 s37, s17
    s_mov_b32 s38, 2211840
    s_mov_b32 s39, 0x20000
    s_mov_b32 s14, 2211840
    s_mov_b32 s15, 0x20000
    s_add_u32 m0, s28, 0
    s_nop 0
    buffer_load_dwordx4 v4, s[36:39], s30 offen lds
    s_add_u32 s30, s30, 27648
    s_add_u32 m0, s28, 1024
    s_nop 0
    buffer_load_dwordx4 v4, s[36:39], s30 offen lds
    s_add_u32 m0, s28, 2048
    s_nop 0
    buffer_load_dwordx4 v4, s[36:39], s31 offen lds
    s_add_u32 s31, s31, 27648
    s_add_u32 m0, s28, 3072
    s_nop 0
    buffer_load_dwordx4 v4, s[36:39], s31 offen lds
    s_cmp_ge_u32 s55, 156
    s_cbranch_scc1 KF_u1b
    s_add_u32 s29, s55, 384
    s_mul_i32 s21, s29, 2428
    s_lshr_b32 s21, s21, 16
    s_mul_i32 s22, s21, 27
    s_sub_u32 s22, s29, s22
    s_mul_i32 s30, s21, 110592
    s_lshl_b32 s23, s22, 7
    s_add_u32 s30, s30, s23
    s_add_u32 s31, s30, 55296
    s_mul_i32 s45, s22, 81920
    s_lshl_b32 s23, s21, 10
    s_add_u32 s45, s45, s23
    s_add_u32 s46, s45, 20480
    s_add_u32 s47, s46, 20480
    s_add_u32 s48, s47, 20480
    s_mov_b32 s49, 0
    s_add_u32 m0, s28, 4096
    s_nop 0
    buffer_load_dwordx4 v4, s[36:39], s30 offen lds
    s_add_u32 s30, s30, 27648
    s_add_u32 m0, s28, 5120
    s_nop 0
    buffer_load_dwordx4 v4, s[36:39], s30 offen lds
    s_add_u32 m0, s28, 6144
    s_nop 0
    buffer_load_dwordx4 v4, s[36:39], s31 offen lds
    s_add_u32 s31, s31, 27648
    s_add_u32 m0, s28, 7168
    s_nop 0
    buffer_load_dwordx4 v4, s[36:39], s31 offen lds
    s_branch KF_u2
KF_u1b:
    s_sub_u32 s29, s55, 156
    s_mul_i32 s22, s29, 6554
    s_lshr_b32 s22, s22, 16
    s_mul_i32 s23, s22, 10
    s_sub_u32 s21, s29, s23
    s_cmp_ge_u32 s22, 52
    s_cselect_b32 s23, 2, 0
    s_add_u32 s22, s22, s23
    s_mul_i32 s23, s22, 9363
    s_lshr_b32 s23, s23, 16
    s_mul_i32 s24, s23, 7
    s_sub_u32 s49, s22, s24
    s_mul_i32 s25, s23, 14
    s_add_u32 s26, s25, 7
    s_min_u32 s26, s26, 101
    s_lshl_b32 s27, s49, 1
    s_add_u32 s30, s25, s27
    s_add_u32 s27, s27, s26
    s_sub_u32 s27, s27, 6
    s_cmp_ge_u32 s49, 3
    s_cselect_b32 s30, s27, s30
    s_add_u32 s31, s30, 1
    s_add_u32 s25, s25, 6
    s_add_u32 s26, s26, 6
    s_cmp_eq_u32 s49, 6
    s_cselect_b32 s30, s25, s30
    s_cselect_b32 s31, s26, s31
    s_lshl_b32 s23, s21, 7
    s_mul_i32 s30, s30, 20480
    s_add_u32 s30, s30, s23
    s_mul_i32 s31, s31, 20480
    s_add_u32 s31, s31, s23
    s_and_b32 s23, s22, 3
    s_mul_i32 s23, s23, 70
    s_lshr_b32 s24, s22, 2
    s_mul_i32 s24, s24, 5
    s_add_u32 s23, s23, s24
    s_add_u32 s23, s23, 2160
    s_lshl_b32 s21, s21, 2
    s_mul_i32 s24, s21, 52
    s_lshr_b32 s24, s24, 8
    s_mul_i32 s25, s24, 275
    s_add_u32 s25, s25, s21
    s_add_u32 s25, s25, s23
    s_lshl_b32 s45, s25, 10
    s_add_u32 s21, s21, 1
    s_mul_i32 s24, s21, 52
    s_lshr_b32 s24, s24, 8
    s_mul_i32 s25, s24, 275
    s_add_u32 s25, s25, s21
    s_add_u32 s25, s25, s23
    s_lshl_b32 s46, s25, 10
    s_add_u32 s21, s21, 1
    s_mul_i32 s24, s21, 52
    s_lshr_b32 s24, s24, 8
    s_mul_i32 s25, s24, 275
    s_add_u32 s25, s25, s21
    s_add_u32 s25, s25, s23
    s_lshl_b32 s47, s25, 10
    s_add_u32 s21, s21, 1
    s_mul_i32 s24, s21, 52
    s_lshr_b32 s24, s24, 8
    s_mul_i32 s25, s24, 275
    s_add_u32 s25, s25, s21
    s_add_u32 s25, s25, s23
    s_lshl_b32 s48, s25, 10
    s_add_u32 m0, s28, 4096
    s_nop 0
    buffer_load_dwordx4 v5, s[12:15], s30 offen lds
    s_add_u32 s30, s30, 10240
    s_add_u32 m0, s28, 5120
    s_nop 0
    buffer_load_dwordx4 v5, s[12:15], s30 offen lds
    s_add_u32 m0, s28, 6144
    s_nop 0
    buffer_load_dwordx4 v5, s[12:15], s31 offen lds
    s_add_u32 s31, s31, 10240
    s_add_u32 m0, s28, 7168
    s_nop 0
    buffer_load_dwordx4 v5, s[12:15], s31 offen lds
KF_u2:
    s_cmp_ge_u32 s55, 312
    s_cbranch_scc1 KF_u3
    s_add_u32 s29, s55, 228
    s_mul_i32 s22, s29, 6554
    s_lshr_b32 s22, s22, 16
    s_mul_i32 s23, s22, 10
    s_sub_u32 s21, s29, s23
    s_cmp_ge_u32 s22, 52
    s_cselect_b32 s23, 2, 0
    s_add_u32 s22, s22, s23
    s_mul_i32 s23, s22, 9363
    s_lshr_b32 s23, s23, 16
    s_mul_i32 s24, s23, 7
    s_sub_u32 s54, s22, s24
    s_mul_i32 s25, s23, 14
    s_add_u32 s26, s25, 7
    s_min_u32 s26, s26, 101
    s_lshl_b32 s27, s54, 1
    s_add_u32 s30, s25, s27
    s_add_u32 s27, s27, s26
    s_sub_u32 s27, s27, 6
    s_cmp_ge_u32 s54, 3
    s_cselect_b32 s30, s27, s30
    s_add_u32 s31, s30, 1
    s_add_u32 s25, s25, 6
    s_add_u32 s26, s26, 6
    s_cmp_eq_u32 s54, 6
    s_cselect_b32 s30, s25, s30
    s_cselect_b32 s31, s26, s31
    s_lshl_b32 s23, s21, 7
    s_mul_i32 s30, s30, 20480
    s_add_u32 s30, s30, s23
    s_mul_i32 s31, s31, 20480
    s_add_u32 s31, s31, s23
    s_and_b32 s23, s22, 3
    s_mul_i32 s23, s23, 70
    s_lshr_b32 s24, s22, 2
    s_mul_i32 s24, s24, 5
    s_add_u32 s23, s23, s24
    s_add_u32 s23, s23, 2160
    s_lshl_b32 s21, s21, 2
    s_mul_i32 s24, s21, 52
    s_lshr_b32 s24, s24, 8
    s_mul_i32 s25, s24, 275
    s_add_u32 s25, s25, s21
    s_add_u32 s25, s25, s23
    s_lshl_b32 s50, s25, 10
    s_add_u32 s21, s21, 1
    s_mul_i32 s24, s21, 52
    s_lshr_b32 s24, s24, 8
    s_mul_i32 s25, s24, 275
    s_add_u32 s25, s25, s21
    s_add_u32 s25, s25, s23
    s_lshl_b32 s51, s25, 10
    s_add_u32 s21, s21, 1
    s_mul_i32 s24, s21, 52
    s_lshr_b32 s24, s24, 8
    s_mul_i32 s25, s24, 275
    s_add_u32 s25, s25, s21
    s_add_u32 s25, s25, s23
    s_lshl_b32 s52, s25, 10
    s_add_u32 s21, s21, 1
    s_mul_i32 s24, s21, 52
    s_lshr_b32 s24, s24, 8
    s_mul_i32 s25, s24, 275
    s_add_u32 s25, s25, s21
    s_add_u32 s25, s25, s23
    s_lshl_b32 s53, s25, 10
    s_add_u32 m0, s28, 8192
    s_nop 0
    buffer_load_dwordx4 v5, s[12:15], s30 offen lds
    s_add_u32 s30, s30, 10240
    s_add_u32 m0, s28, 9216
    s_nop 0
    buffer_load_dwordx4 v5, s[12:15], s30 offen lds
    s_add_u32 m0, s28, 10240
    s_nop 0
    buffer_load_dwordx4 v5, s[12:15], s31 offen lds
    s_add_u32 s31, s31, 10240
    s_add_u32 m0, s28, 11264
    s_nop 0
    buffer_load_dwordx4 v5, s[12:15], s31 offen lds
KF_u3:
    s_add_u32 s56, s18, 5373952
    s_addc_u32 s57, s19, 0
    s_mov_b32 s58, 4505600
    s_mov_b32 s59, 0x20000
    s_add_u32 s64, s18, 9895936
    s_addc_u32 s65, s19, 0
    s_mov_b32 s66, 106496
    s_mov_b32 s67, 0x20000
    s_branch KF_k3setup
KF_k2done:
KF_k3setup:
    s_mov_b32 s21, s73
    s_mov_b32 s12, s4
    s_mov_b32 s13, s5
    s_mov_b32 s14, 2621440
    s_mov_b32 s15, 0x20000
    v_lshrrev_b32 v55, 5, v1
    v_and_b32 v56, 31, v1
    v_mul_u32_u24 v57, 0x500, v55
    v_lshl_add_u32 v126, v56, 3, v57
    s_lshl_b32 s23, s21, 3
    s_lshl_b32 s24, s20, 1
    s_add_u32 s23, s23, s24
    s_mul_i32 s23, s23, 1280
    buffer_load_dwordx2 v[196:197], v126, s[12:15], s23 offen offset:0
    buffer_load_dwordx2 v[198:199], v126, s[12:15], s23 offen offset:256
    buffer_load_dwordx2 v[200:201], v126, s[12:15], s23 offen offset:512
    buffer_load_dwordx2 v[202:203], v126, s[12:15], s23 offen offset:768
    buffer_load_dwordx2 v[204:205], v126, s[12:15], s23 offen offset:1024
    s_mov_b32 s12, s6
    s_mov_b32 s13, s7
    s_mov_b32 s14, 3456
    s_mov_b32 s15, 0x20000
    v_lshrrev_b32 v57, 4, v1
    v_lshlrev_b32 v57, 3, v57
    s_lshl_b32 s27, s74, 5
    buffer_load_dwordx2 v[232:233], v57, s[12:15], s27 offen offset:0
    buffer_load_dwordx2 v[234:235], v57, s[12:15], s27 offen offset:32
    buffer_load_dwordx2 v[236:237], v57, s[12:15], s27 offen offset:64
    buffer_load_dwordx2 v[238:239], v57, s[12:15], s27 offen offset:96
    buffer_load_dwordx2 v[240:241], v57, s[12:15], s27 offen offset:128
    buffer_load_dwordx2 v[242:243], v57, s[12:15], s27 offen offset:160
    buffer_load_dwordx2 v[244:245], v57, s[12:15], s27 offen offset:192
    v_and_b32 v53, 15, v1
    v_lshrrev_b32 v54, 4, v1
    s_lshl_b32 s24, s20, 4
    v_add_u32 v50, s24, v53
    v_lshlrev_b32 v51, 2, v54
    v_and_b32 v49, 16, v1
    s_mov_b32 s26, 8320
    s_mov_b32 s24, 0x24130
    s_mov_b32 s25, 10668340
    v_mul_u32_u24 v100, 52, v50
    v_lshrrev_b32 v100, 8, v100
    v_mul_u32_u24 v100, 5, v100
    v_sub_u32 v100, v50, v100
    v_mul_u32_u24 v101, 5, v100
    v_lshrrev_b32 v101, v101, s25
    v_bfe_i32 v121, v101, 0, 1
    v_and_b32 v121, 0x80008000, v121
    v_bfe_i32 v122, v101, 1, 1
    v_and_b32 v122, 0x80008000, v122
    v_bfe_i32 v123, v101, 2, 1
    v_and_b32 v123, 0x80008000, v123
    v_bfe_i32 v124, v101, 3, 1
    v_and_b32 v124, 0x80008000, v124
    v_bfe_i32 v125, v101, 4, 1
    v_and_b32 v125, 0x80008000, v125
    v_lshlrev_b32 v100, 2, v100
    v_bfe_u32 v100, s24, v100, 3
    v_lshl_add_u32 v100, v55, 1, v100
    v_add_u32 v101, -5, v100
    v_min_u32 v100, v100, v101
    v_lshl_add_u32 v101, v100, 7, v50
    v_sub_u32 v102, 0x280, v101
    v_min_u32 v102, v102, v101
    v_mad_u32_u24 v116, v102, s26, v49
    v_add_u32 v101, 4, v100
    v_add_u32 v100, -1, v100
    v_min_u32 v100, v100, v101
    v_lshl_add_u32 v101, v100, 7, v50
    v_sub_u32 v102, 0x280, v101
    v_min_u32 v102, v102, v101
    v_mad_u32_u24 v117, v102, s26, v49
    v_add_u32 v101, 4, v100
    v_add_u32 v100, -1, v100
    v_min_u32 v100, v100, v101
    v_lshl_add_u32 v101, v100, 7, v50
    v_sub_u32 v102, 0x280, v101
    v_min_u32 v102, v102, v101
    v_mad_u32_u24 v118, v102, s26, v49
    s_cmp_lg_u32 s20, 0
    s_cbranch_scc1 K3_nosp1
    s_mov_b32 exec_lo, 0x00010001
    s_mov_b32 exec_hi, 0x00010001
    v_mul_u32_u24 v100, 2129920, v55
    v_add_u32 v100, 0, v100
    v_add_u32 v116, v100, v49
    v_mul_u32_u24 v100, 532480, v55
    v_add_u32 v100, 1064960, v100
    v_add_u32 v117, v100, v49
    v_mov_b32 v100, 0
    v_add_u32 v100, 532480, v100
    v_add_u32 v118, v100, v49
    v_mov_b32 v121, 0
    v_mov_b32 v122, 0
    v_mov_b32 v123, 0x80008000
    v_mov_b32 v124, 0
    v_mov_b32 v125, 0x80008000
    s_mov_b64 exec, -1
K3_nosp1:
    v_lshrrev_b32 v57, 3, v56
    v_lshlrev_b32 v57, 7, v57
    v_and_b32 v58, 3, v56
    v_lshl_add_u32 v57, v58, 5, v57
    v_lshl_add_u32 v57, v55, 4, v57
    v_and_b32 v58, 4, v56
    v_lshl_add_u32 v57, v58, 1, v57
    s_mul_i32 s24, s20, 2624
    s_add_u32 s24, s24, 143360
    v_add_u32 v127, s24, v57
    v_bfe_u32 v57, v1, 1, 2
    v_mul_u32_u24 v57, 2624, v57
    v_and_b32 v58, 1, v1
    v_lshl_add_u32 v57, v58, 4, v57
    v_lshrrev_b32 v58, 3, v1
    v_lshl_add_u32 v57, v58, 5, v57
    s_mul_i32 s24, s20, 1280
    s_add_u32 s24, s24, 143360
    v_add_u32 v120, s24, v57
    v_and_b32 v57, 7, v1
    v_lshlrev_b32 v57, 4, v57
    v_lshl_add_u32 v119, v58, 8, v57
    s_mul_i32 s24, s20, 2624
    s_add_u32 s24, s24, 143360
    v_lshl_add_u32 v62, v56, 4, s24
    v_mul_u32_u24 v63, 0x202, v55
    v_lshlrev_b32 v63, 16, v63
    v_add_u32 v63, 0x01000c0c, v63
    v_lshrrev_b32 v57, 2, v53
    v_xor_b32 v57, v57, v54
    v_lshlrev_b32 v57, 3, v57
    v_lshl_add_u32 v60, v50, 5, v57
    v_add_u32 v60, 143360, v60
    v_and_b32 v57, 3, v1
    v_xor_b32 v57, v57, v54
    v_lshlrev_b32 v57, 3, v57
    v_lshrrev_b32 v58, 2, v1
    v_lshl_add_u32 v61, v58, 5, v57
    v_add_u32 v61, 143360, v61
    s_lshl_b32 s24, s20, 5
    v_add_u32 v52, s24, v53
    v_mul_u32_u24 v57, 20, v52
    v_mul_u32_u24 v58, 2624, v54
    v_add_u32 v58, 143360, v58
    v_add_u32 v106, v57, v58
    v_add_u32 v59, 512, v57
    v_add_u32 v100, -2048, v57
    v_min_u32 v59, v59, v100
    v_add_u32 v107, v59, v58
    v_add_u32 v59, 1024, v57
    v_add_u32 v100, -1536, v57
    v_min_u32 v59, v59, v100
    v_add_u32 v108, v59, v58
    v_add_u32 v59, 1536, v57
    v_add_u32 v100, -1024, v57
    v_min_u32 v59, v59, v100
    v_add_u32 v109, v59, v58
    v_add_u32 v59, 2048, v57
    v_add_u32 v100, -512, v57
    v_min_u32 v59, v59, v100
    v_add_u32 v110, v59, v58
    v_add_u32 v111, 0x140, v106
    v_add_u32 v59, 832, v57
    v_add_u32 v100, -1728, v57
    v_min_u32 v59, v59, v100
    v_add_u32 v112, v59, v58
    v_add_u32 v59, 1344, v57
    v_add_u32 v100, -1216, v57
    v_min_u32 v59, v59, v100
    v_add_u32 v113, v59, v58
    v_add_u32 v59, 1856, v57
    v_add_u32 v100, -704, v57
    v_min_u32 v59, v59, v100
    v_add_u32 v114, v59, v58
    v_add_u32 v59, 2368, v57
    v_add_u32 v100, -192, v57
    v_min_u32 v59, v59, v100
    v_add_u32 v115, v59, v58
    v_cvt_f32_u32 v98, v51
    v_lshlrev_b32 v99, 31, v1
    v_or_b32 v99, 0.5, v99
    v_cvt_f32_u32 v96, v52
    v_mul_f32 v96, 0xbc000000, v96
    v_mul_f32 v97, 0x41500000, v96
    v_mul_f32 v22, v98, v96
    v_add_f32 v23, v22, v96
    v_add_f32 v24, v23, v96
    v_add_f32 v25, v24, v96
    v_add_f32 v26, v25, v97
    v_add_f32 v27, v26, v96
    v_add_f32 v28, v27, v96
    v_add_f32 v29, v28, v96
    v_cos_f32 v30, v22
    v_cos_f32 v31, v23
    v_cos_f32 v32, v24
    v_cos_f32 v33, v25
    v_cos_f32 v34, v26
    v_cos_f32 v35, v27
    v_cos_f32 v36, v28
    v_cos_f32 v37, v29
    v_sin_f32 v38, v22
    v_sin_f32 v39, v23
    v_sin_f32 v40, v24
    v_sin_f32 v41, v25
    v_sin_f32 v42, v26
    v_sin_f32 v43, v27
    v_sin_f32 v44, v28
    v_sin_f32 v45, v29
    s_mov_b64 exec, 0xffff
    v_mov_b32 v30, 0.5
    v_mov_b32 v38, v99
    s_mov_b64 exec, -1
    v_cvt_pk_bf16_f32 v64, v30, v31
    v_cvt_pk_bf16_f32 v65, v32, v33
    v_cvt_pk_bf16_f32 v66, v34, v35
    v_cvt_pk_bf16_f32 v67, v36, v37
    v_cvt_pk_bf16_f32 v80, v38, v39
    v_cvt_pk_bf16_f32 v81, v40, v41
    v_cvt_pk_bf16_f32 v82, v42, v43
    v_cvt_pk_bf16_f32 v83, v44, v45
    v_add_f32 v22, v29, v97
    v_add_f32 v23, v22, v96
    v_add_f32 v24, v23, v96
    v_add_f32 v25, v24, v96
    v_add_f32 v26, v25, v97
    v_add_f32 v27, v26, v96
    v_add_f32 v28, v27, v96
    v_add_f32 v29, v28, v96
    v_cos_f32 v30, v22
    v_cos_f32 v31, v23
    v_cos_f32 v32, v24
    v_cos_f32 v33, v25
    v_cos_f32 v34, v26
    v_cos_f32 v35, v27
    v_cos_f32 v36, v28
    v_cos_f32 v37, v29
    v_sin_f32 v38, v22
    v_sin_f32 v39, v23
    v_sin_f32 v40, v24
    v_sin_f32 v41, v25
    v_sin_f32 v42, v26
    v_sin_f32 v43, v27
    v_sin_f32 v44, v28
    v_sin_f32 v45, v29
    v_cvt_pk_bf16_f32 v68, v30, v31
    v_cvt_pk_bf16_f32 v69, v32, v33
    v_cvt_pk_bf16_f32 v70, v34, v35
    v_cvt_pk_bf16_f32 v71, v36, v37
    v_cvt_pk_bf16_f32 v84, v38, v39
    v_cvt_pk_bf16_f32 v85, v40, v41
    v_cvt_pk_bf16_f32 v86, v42, v43
    v_cvt_pk_bf16_f32 v87, v44, v45
    s_cmp_lt_u32 s2, 64
    s_cbranch_scc1 KF_mb
    s_cmp_lt_u32 s20, 2
    s_cbranch_scc1 KF_mb
    v_lshrrev_b32 v6, 4, v1
    v_bfe_u32 v7, v1, 2, 2
    s_waitcnt vmcnt(12)
    s_cmp_eq_u32 s44, 6
    s_cselect_b32 s21, 8, 4
    s_cselect_b32 s22, 64, 0
    s_movk_i32 s23, 0x800
    s_cselect_b32 s23, 0x200, s23
    v_mad_u32_u24 v8, v6, s21, v7
    v_bfe_u32 v9, v1, 1, 1
    v_xor_b32 v9, v9, v8
    v_and_b32 v9, 7, v9
    v_lshlrev_b32 v9, 4, v9
    v_lshl_add_u32 v9, v8, 7, v9
    v_and_b32 v8, 1, v1
    v_lshl_add_u32 v9, v8, 3, v9
    v_add_u32 v128, s28, v9
    v_xor_b32 v132, s22, v128
    v_add_u32 v132, s23, v132
    v_xor_b32 v129, 32, v128
    v_xor_b32 v133, 32, v132
    v_xor_b32 v130, 64, v128
    v_xor_b32 v134, 64, v132
    v_xor_b32 v131, 96, v128
    v_xor_b32 v135, 96, v132
    ds_read_b64_tr_b16 v[136:137], v128 offset:0
    ds_read_b64_tr_b16 v[138:139], v132 offset:0
    ds_read_b64_tr_b16 v[140:141], v129 offset:0
    ds_read_b64_tr_b16 v[142:143], v133 offset:0
    ds_read_b64_tr_b16 v[144:145], v130 offset:0
    ds_read_b64_tr_b16 v[146:147], v134 offset:0
    ds_read_b64_tr_b16 v[148:149], v131 offset:0
    ds_read_b64_tr_b16 v[150:151], v135 offset:0
    s_waitcnt lgkmcnt(6)
    buffer_store_dwordx4 v[136:139], v0, s[56:59], s40 offen sc1
    s_waitcnt lgkmcnt(4)
    buffer_store_dwordx4 v[140:143], v0, s[56:59], s41 offen sc1
    s_waitcnt lgkmcnt(2)
    buffer_store_dwordx4 v[144:147], v0, s[56:59], s42 offen sc1
    s_waitcnt lgkmcnt(0)
    buffer_store_dwordx4 v[148:151], v0, s[56:59], s43 offen sc1
    s_cmp_eq_u32 s49, 6
    s_cselect_b32 s21, 8, 4
    s_cselect_b32 s22, 64, 0
    s_movk_i32 s23, 0x800
    s_cselect_b32 s23, 0x200, s23
    v_mad_u32_u24 v8, v6, s21, v7
    v_bfe_u32 v9, v1, 1, 1
    v_xor_b32 v9, v9, v8
    v_and_b32 v9, 7, v9
    v_lshlrev_b32 v9, 4, v9
    v_lshl_add_u32 v9, v8, 7, v9
    v_and_b32 v8, 1, v1
    v_lshl_add_u32 v9, v8, 3, v9
    v_add_u32 v128, s28, v9
    v_xor_b32 v132, s22, v128
    v_add_u32 v132, s23, v132
    v_xor_b32 v129, 32, v128
    v_xor_b32 v133, 32, v132
    v_xor_b32 v130, 64, v128
    v_xor_b32 v134, 64, v132
    v_xor_b32 v131, 96, v128
    v_xor_b32 v135, 96, v132
    ds_read_b64_tr_b16 v[152:153], v128 offset:4096
    ds_read_b64_tr_b16 v[154:155], v132 offset:4096
    ds_read_b64_tr_b16 v[156:157], v129 offset:4096
    ds_read_b64_tr_b16 v[158:159], v133 offset:4096
    ds_read_b64_tr_b16 v[160:161], v130 offset:4096
    ds_read_b64_tr_b16 v[162:163], v134 offset:4096
    ds_read_b64_tr_b16 v[164:165], v131 offset:4096
    ds_read_b64_tr_b16 v[166:167], v135 offset:4096
    s_waitcnt lgkmcnt(6)
    buffer_store_dwordx4 v[152:155], v0, s[56:59], s45 offen sc1
    s_waitcnt lgkmcnt(4)
    buffer_store_dwordx4 v[156:159], v0, s[56:59], s46 offen sc1
    s_waitcnt lgkmcnt(2)
    buffer_store_dwordx4 v[160:163], v0, s[56:59], s47 offen sc1
    s_waitcnt lgkmcnt(0)
    buffer_store_dwordx4 v[164:167], v0, s[56:59], s48 offen sc1
    s_cmp_ge_u32 s55, 312
    s_cbranch_scc1 KF_us2
    s_cmp_eq_u32 s54, 6
    s_cselect_b32 s21, 8, 4
    s_cselect_b32 s22, 64, 0
    s_movk_i32 s23, 0x800
    s_cselect_b32 s23, 0x200, s23
    v_mad_u32_u24 v8, v6, s21, v7
    v_bfe_u32 v9, v1, 1, 1
    v_xor_b32 v9, v9, v8
    v_and_b32 v9, 7, v9
    v_lshlrev_b32 v9, 4, v9
    v_lshl_add_u32 v9, v8, 7, v9
    v_and_b32 v8, 1, v1
    v_lshl_add_u32 v9, v8, 3, v9
    v_add_u32 v128, s28, v9
    v_xor_b32 v132, s22, v128
    v_add_u32 v132, s23, v132
    v_xor_b32 v129, 32, v128
    v_xor_b32 v133, 32, v132
    v_xor_b32 v130, 64, v128
    v_xor_b32 v134, 64, v132
    v_xor_b32 v131, 96, v128
    v_xor_b32 v135, 96, v132
    ds_read_b64_tr_b16 v[168:169], v128 offset:8192
    ds_read_b64_tr_b16 v[170:171], v132 offset:8192
    ds_read_b64_tr_b16 v[172:173], v129 offset:8192
    ds_read_b64_tr_b16 v[174:175], v133 offset:8192
    ds_read_b64_tr_b16 v[176:177], v130 offset:8192
    ds_read_b64_tr_b16 v[178:179], v134 offset:8192
    ds_read_b64_tr_b16 v[180:181], v131 offset:8192
    ds_read_b64_tr_b16 v[182:183], v135 offset:8192
    s_waitcnt lgkmcnt(6)
    buffer_store_dwordx4 v[168:171], v0, s[56:59], s50 offen sc1
    s_waitcnt lgkmcnt(4)
    buffer_store_dwordx4 v[172:175], v0, s[56:59], s51 offen sc1
    s_waitcnt lgkmcnt(2)
    buffer_store_dwordx4 v[176:179], v0, s[56:59], s52 offen sc1
    s_waitcnt lgkmcnt(0)
    buffer_store_dwordx4 v[180:183], v0, s[56:59], s53 offen sc1
KF_us2:
    s_nop 0
    s_branch KF_md
KF_mb:
    s_lshl_b32 s21, s20, 2
    s_add_u32 s21, s21, 159744
    v_mov_b32 v2, s21
    v_mov_b32 v3, 1
    s_lshr_b32 s21, s2, 2
    s_lshl_b32 s21, s21, 7
    s_and_b32 s22, s2, 3
    s_lshl_b32 s22, s22, 2
    s_add_u32 s21, s21, s22
    s_waitcnt vmcnt(12)
    s_cmp_eq_u32 s20, 0
    s_cbranch_scc1 KF_w0
    ds_write_b32 v2, v3
    s_branch KF_pbd
KF_w0:
    s_mov_b32 s72, 32768
KF_sp:
    ds_read_b128 v[4:7], v2
    s_waitcnt lgkmcnt(0)
    v_min3_u32 v4, v5, v6, v7
    v_cmp_eq_u32 vcc, 0, v4
    s_sub_u32 s72, s72, 1
    s_nop 2
    s_cbranch_scc1 KF_spd
    s_cbranch_vccnz KF_sp
KF_spd:
    v_lshlrev_b32 v2, 13, v1
    s_add_u32 s21, s21, 40960
    s_mov_b64 exec, 15
    buffer_store_dword v3, v2, s[64:67], s21 offen sc0 sc1
    s_mov_b64 exec, -1
KF_pbd:
KF_md:
    v_add_u32 v52, 16, v52
    v_cvt_f32_u32 v96, v52
    v_mul_f32 v96, 0xbc000000, v96
    v_mul_f32 v97, 0x41500000, v96
    v_mul_f32 v22, v98, v96
    v_add_f32 v23, v22, v96
    v_add_f32 v24, v23, v96
    v_add_f32 v25, v24, v96
    v_add_f32 v26, v25, v97
    v_add_f32 v27, v26, v96
    v_add_f32 v28, v27, v96
    v_add_f32 v29, v28, v96
    v_cos_f32 v30, v22
    v_cos_f32 v31, v23
    v_cos_f32 v32, v24
    v_cos_f32 v33, v25
    v_cos_f32 v34, v26
    v_cos_f32 v35, v27
    v_cos_f32 v36, v28
    v_cos_f32 v37, v29
    v_sin_f32 v38, v22
    v_sin_f32 v39, v23
    v_sin_f32 v40, v24
    v_sin_f32 v41, v25
    v_sin_f32 v42, v26
    v_sin_f32 v43, v27
    v_sin_f32 v44, v28
    v_sin_f32 v45, v29
    s_mov_b64 exec, 0xffff
    v_mov_b32 v30, 0.5
    v_mov_b32 v38, v99
    s_mov_b64 exec, -1
    v_cvt_pk_bf16_f32 v72, v30, v31
    v_cvt_pk_bf16_f32 v73, v32, v33
    v_cvt_pk_bf16_f32 v74, v34, v35
    v_cvt_pk_bf16_f32 v75, v36, v37
    v_cvt_pk_bf16_f32 v88, v38, v39
    v_cvt_pk_bf16_f32 v89, v40, v41
    v_cvt_pk_bf16_f32 v90, v42, v43
    v_cvt_pk_bf16_f32 v91, v44, v45
    v_add_f32 v22, v29, v97
    v_add_f32 v23, v22, v96
    v_add_f32 v24, v23, v96
    v_add_f32 v25, v24, v96
    v_add_f32 v26, v25, v97
    v_add_f32 v27, v26, v96
    v_add_f32 v28, v27, v96
    v_add_f32 v29, v28, v96
    v_cos_f32 v30, v22
    v_cos_f32 v31, v23
    v_cos_f32 v32, v24
    v_cos_f32 v33, v25
    v_cos_f32 v34, v26
    v_cos_f32 v35, v27
    v_cos_f32 v36, v28
    v_cos_f32 v37, v29
    v_sin_f32 v38, v22
    v_sin_f32 v39, v23
    v_sin_f32 v40, v24
    v_sin_f32 v41, v25
    v_sin_f32 v42, v26
    v_sin_f32 v43, v27
    v_sin_f32 v44, v28
    v_sin_f32 v45, v29
    v_cvt_pk_bf16_f32 v76, v30, v31
    v_cvt_pk_bf16_f32 v77, v32, v33
    v_cvt_pk_bf16_f32 v78, v34, v35
    v_cvt_pk_bf16_f32 v79, v36, v37
    v_cvt_pk_bf16_f32 v92, v38, v39
    v_cvt_pk_bf16_f32 v93, v40, v41
    v_cvt_pk_bf16_f32 v94, v42, v43
    v_cvt_pk_bf16_f32 v95, v44, v45
    s_cmp_lt_u32 s2, 64
    s_cbranch_scc1 KF_late
    s_cmp_lt_u32 s20, 2
    s_cbranch_scc1 KF_late
    s_lshl_b32 s21, s20, 2
    s_add_u32 s21, s21, 159744
    v_mov_b32 v2, s21
    v_mov_b32 v3, 1
    s_waitcnt vmcnt(0)
    ds_write_b32 v2, v3
KF_late:
    s_add_u32 s8, s18, 10027008
    s_addc_u32 s9, s19, 0
    s_mov_b32 s10, 2662400
    s_mov_b32 s11, 0x20000
    s_add_u32 s28, s18, 15335424
    s_addc_u32 s29, s19, 0
    s_mov_b32 s30, 2621440
    s_mov_b32 s31, 0x20000
    s_add_u32 s32, s18, 12713984
    s_addc_u32 s33, s19, 0
    s_mov_b32 s34, 2621440
    s_mov_b32 s35, 0x20000
    s_lshl_b32 s22, s73, 5
    s_lshl_b32 s23, s73, 3
    s_lshl_b32 s24, s20, 1
    s_add_u32 s23, s23, s24
    s_mul_i32 s23, s23, 1280
    s_lshr_b32 s50, s73, 1
    s_mul_i32 s50, s50, 20480
    s_and_b32 s24, s73, 1
    s_lshl_b32 s24, s24, 7
    s_add_u32 s50, s50, s24
    s_mul_i32 s24, s20, 10240
    s_add_u32 s50, s50, s24
    s_add_u32 s51, s50, 4096
    s_add_u32 s52, s51, 4096
    s_mov_b32 s40, 0x3e9e377a
    s_mov_b32 s42, 0xbf4f1bbd
    s_mov_b32 s44, 0x3f737871
    s_mov_b32 s46, 0x3f167918
    s_lshr_b32 s70, s3, 3
    s_and_b32 s70, s70, 2
    s_add_u32 s70, s70, s20
    s_and_b32 s70, s70, 3
    s_mul_i32 s70, s70, 4096
    s_mul_i32 s68, s74, 20480
    s_add_u32 s68, s68, s70
    s_and_b32 s21, s2, 3
    s_lshl_b32 s21, s21, 13
    s_add_u32 s21, s21, 40960
    s_cmp_lg_u32 s20, 0
    s_cbranch_scc1 KF_pd1
    v_lshlrev_b32 v210, 7, v1
    s_mov_b32 s72, 32768
KF_pl1:
    buffer_load_dwordx4 v[206:209], v210, s[64:67], s21 offen sc0 sc1
    s_waitcnt vmcnt(0)
    v_min_u32 v206, v206, v207
    v_min3_u32 v206, v206, v208, v209
    v_cmp_eq_u32 vcc, 0, v206
    s_sub_u32 s72, s72, 1
    s_nop 2
    s_cbranch_scc1 KF_pe1
    s_cbranch_vccz KF_pe1
    s_mov_b64 exec, vcc
    s_branch KF_pl1
KF_pe1:
    s_mov_b64 exec, -1
KF_pd1:
    s_barrier
    buffer_load_dwordx4 v[2:5], v116, s[8:11], s22 offen
    buffer_load_dwordx4 v[6:9], v117, s[8:11], s22 offen
    s_mov_b32 exec_hi, 0
    buffer_load_dwordx4 v[10:13], v118, s[8:11], s22 offen
    s_mov_b32 exec_hi, -1
    s_mov_b32 m0, s70
    s_nop 0
    buffer_load_dwordx4 v0, s[56:59], s68 offen offset:0 lds
    buffer_load_dwordx4 v0, s[56:59], s68 offen offset:1024 lds
    buffer_load_dwordx4 v0, s[56:59], s68 offen offset:2048 lds
    buffer_load_dwordx4 v0, s[56:59], s68 offen offset:3072 lds
    s_add_u32 s68, s68, 20480
    s_add_u32 s70, s70, 20480
    s_mov_b32 m0, s70
    s_nop 0
    buffer_load_dwordx4 v0, s[56:59], s68 offen offset:0 lds
    buffer_load_dwordx4 v0, s[56:59], s68 offen offset:1024 lds
    buffer_load_dwordx4 v0, s[56:59], s68 offen offset:2048 lds
    buffer_load_dwordx4 v0, s[56:59], s68 offen offset:3072 lds
    s_add_u32 s68, s68, 20480
    s_add_u32 s70, s70, 20480
    s_mov_b32 m0, s70
    s_nop 0
    buffer_load_dwordx4 v0, s[56:59], s68 offen offset:0 lds
    buffer_load_dwordx4 v0, s[56:59], s68 offen offset:1024 lds
    buffer_load_dwordx4 v0, s[56:59], s68 offen offset:2048 lds
    s_waitcnt vmcnt(14)
    v_lshlrev_b32 v176, 16, v196
    v_and_b32 v177, 0xffff0000, v196
    v_lshlrev_b32 v178, 16, v197
    v_and_b32 v179, 0xffff0000, v197
    v_lshlrev_b32 v180, 16, v198
    v_and_b32 v181, 0xffff0000, v198
    v_lshlrev_b32 v182, 16, v199
    v_and_b32 v183, 0xffff0000, v199
    v_lshlrev_b32 v184, 16, v200
    v_and_b32 v185, 0xffff0000, v200
    v_lshlrev_b32 v186, 16, v201
    v_and_b32 v187, 0xffff0000, v201
    v_lshlrev_b32 v188, 16, v202
    v_and_b32 v189, 0xffff0000, v202
    v_lshlrev_b32 v190, 16, v203
    v_and_b32 v191, 0xffff0000, v203
    v_lshlrev_b32 v192, 16, v204
    v_and_b32 v193, 0xffff0000, v204
    v_lshlrev_b32 v194, 16, v205
    v_and_b32 v195, 0xffff0000, v205
    s_waitcnt vmcnt(11)
    v_permlane32_swap_b32 v2, v4
    v_permlane32_swap_b32 v3, v5
    v_permlane32_swap_b32 v6, v8
    v_permlane32_swap_b32 v7, v9
    v_permlane32_swap_b32 v10, v12
    v_permlane32_swap_b32 v11, v13
    v_permlane16_swap_b32 v2, v3
    v_permlane16_swap_b32 v4, v5
    v_permlane16_swap_b32 v6, v7
    v_permlane16_swap_b32 v8, v9
    buffer_load_dwordx4 v0, s[56:59], s68 offen offset:3072 lds
    v_permlane16_swap_b32 v10, v11
    v_permlane16_swap_b32 v12, v13
    v_xor_b32 v3, v3, v121
    v_lshlrev_b32 v22, 16, v2
    v_and_b32 v23, 0xffff0000, v2
    v_lshlrev_b32 v24, 16, v3
    v_and_b32 v25, 0xffff0000, v3
    v_xor_b32 v5, v5, v122
    v_lshlrev_b32 v26, 16, v4
    v_and_b32 v27, 0xffff0000, v4
    s_add_u32 s68, s68, 20480
    s_add_u32 s70, s70, 20480
    s_mov_b32 m0, s70
    s_nop 0
    buffer_load_dwordx4 v0, s[56:59], s68 offen offset:0 lds
    v_lshlrev_b32 v28, 16, v5
    v_and_b32 v29, 0xffff0000, v5
    v_xor_b32 v7, v7, v123
    v_lshlrev_b32 v30, 16, v6
    v_and_b32 v31, 0xffff0000, v6
    v_lshlrev_b32 v32, 16, v7
    v_and_b32 v33, 0xffff0000, v7
    v_xor_b32 v9, v9, v124
    v_lshlrev_b32 v34, 16, v8
    v_and_b32 v35, 0xffff0000, v8
    buffer_load_dwordx4 v0, s[56:59], s68 offen offset:1024 lds
    v_lshlrev_b32 v36, 16, v9
    v_and_b32 v37, 0xffff0000, v9
    v_xor_b32 v11, v11, v125
    v_lshlrev_b32 v38, 16, v10
    v_and_b32 v39, 0xffff0000, v10
    v_lshlrev_b32 v40, 16, v11
    v_and_b32 v41, 0xffff0000, v11
    s_cmp_lg_u32 s20, 0
    s_cbranch_scc1 K3_nosp2
    s_mov_b32 exec_lo, 0x00010001
    s_mov_b32 exec_hi, 0x00010001
    v_mov_b32 v2, v38
    v_mov_b32 v3, v39
    v_pk_add_f32 v[38:39], v[26:27], v[40:41]
    v_pk_add_f32 v[26:27], v[26:27], v[40:41] neg_lo:[0,1] neg_hi:[0,1]
    v_pk_add_f32 v[40:41], v[2:3], v[28:29] neg_lo:[0,1] neg_hi:[0,1]
    v_pk_add_f32 v[28:29], v[28:29], v[2:3]
    v_mov_b32 v2, v34
    v_mov_b32 v3, v35
    v_pk_add_f32 v[34:35], v[30:31], v[36:37]
    v_pk_add_f32 v[30:31], v[30:31], v[36:37] neg_lo:[0,1] neg_hi:[0,1]
    v_pk_add_f32 v[36:37], v[2:3], v[32:33] neg_lo:[0,1] neg_hi:[0,1]
    v_pk_add_f32 v[32:33], v[32:33], v[2:3]
    v_mov_b32 v24, v22
    v_mov_b32 v25, v23
    v_mov_b32 v22, 0
    v_mov_b32 v23, 0
    s_mov_b64 exec, -1
K3_nosp2:
    v_pk_add_f32 v[128:129], v[26:27], v[38:39]
    v_pk_add_f32 v[132:133], v[30:31], v[34:35]
    v_pk_add_f32 v[136:137], v[26:27], v[38:39] neg_lo:[0,1] neg_hi:[0,1]
    buffer_load_dwordx4 v0, s[56:59], s68 offen offset:2048 lds
    v_pk_add_f32 v[140:141], v[30:31], v[34:35] neg_lo:[0,1] neg_hi:[0,1]
    v_pk_add_f32 v[130:131], v[28:29], v[40:41]
    v_pk_add_f32 v[134:135], v[32:33], v[36:37]
    v_pk_add_f32 v[138:139], v[28:29], v[40:41] neg_lo:[0,1] neg_hi:[0,1]
    v_pk_add_f32 v[142:143], v[32:33], v[36:37] neg_lo:[0,1] neg_hi:[0,1]
    v_pk_fma_f32 v[144:145], v[128:129], s[40:41], v[22:23] op_sel_hi:[1,0,1]
    v_pk_fma_f32 v[148:149], v[128:129], s[42:43], v[22:23] op_sel_hi:[1,0,1]
    v_pk_mul_f32 v[152:153], v[136:137], s[44:45] op_sel_hi:[1,0]
    v_pk_mul_f32 v[156:157], v[136:137], s[46:47] op_sel_hi:[1,0]
    v_pk_add_f32 v[160:161], v[128:129], v[22:23]
    buffer_load_dwordx4 v0, s[56:59], s68 offen offset:3072 lds
    v_pk_fma_f32 v[146:147], v[130:131], s[40:41], v[24:25] op_sel_hi:[1,0,1]
    v_pk_fma_f32 v[150:151], v[130:131], s[42:43], v[24:25] op_sel_hi:[1,0,1]
    v_pk_mul_f32 v[154:155], v[138:139], s[44:45] op_sel_hi:[1,0]
    v_pk_mul_f32 v[158:159], v[138:139], s[46:47] op_sel_hi:[1,0]
    v_pk_add_f32 v[162:163], v[130:131], v[24:25]
    v_pk_fma_f32 v[144:145], v[132:133], s[42:43], v[144:145] op_sel_hi:[1,0,1]
    v_pk_fma_f32 v[148:149], v[132:133], s[40:41], v[148:149] op_sel_hi:[1,0,1]
    v_pk_fma_f32 v[152:153], v[140:141], s[46:47], v[152:153] op_sel_hi:[1,0,1]
    v_pk_fma_f32 v[156:157], v[140:141], s[44:45], v[156:157] op_sel_hi:[1,0,1] neg_lo:[1,0,0] neg_hi:[1,0,0]
    v_pk_add_f32 v[160:161], v[160:161], v[132:133]
    s_add_u32 s68, s68, 20480
    s_add_u32 s70, s70, 20480
    s_mov_b32 m0, s70
    s_nop 0
    buffer_load_dwordx4 v0, s[56:59], s68 offen offset:0 lds
    v_pk_fma_f32 v[146:147], v[134:135], s[42:43], v[146:147] op_sel_hi:[1,0,1]
    v_pk_fma_f32 v[150:151], v[134:135], s[40:41], v[150:151] op_sel_hi:[1,0,1]
    v_pk_fma_f32 v[154:155], v[142:143], s[46:47], v[154:155] op_sel_hi:[1,0,1]
    v_pk_fma_f32 v[158:159], v[142:143], s[44:45], v[158:159] op_sel_hi:[1,0,1] neg_lo:[1,0,0] neg_hi:[1,0,0]
    v_pk_add_f32 v[162:163], v[162:163], v[134:135]
    v_cvt_pk_bf16_f32 v2, v160, v161
    v_cvt_pk_bf16_f32 v4, v162, v163
    v_pk_add_f32 v[128:129], v[144:145], v[154:155] neg_lo:[0,1] neg_hi:[0,1]
    v_pk_add_f32 v[130:131], v[146:147], v[152:153]
    v_pk_add_f32 v[132:133], v[144:145], v[154:155]
    buffer_load_dwordx4 v0, s[56:59], s68 offen offset:1024 lds
    v_pk_add_f32 v[134:135], v[146:147], v[152:153] neg_lo:[0,1] neg_hi:[0,1]
    v_cvt_pk_bf16_f32 v22, v132, v133
    v_cvt_pk_bf16_f32 v23, v134, v135
    v_cvt_pk_bf16_f32 v3, v128, v129
    v_cvt_pk_bf16_f32 v5, v130, v131
    v_pk_add_f32 v[136:137], v[148:149], v[158:159] neg_lo:[0,1] neg_hi:[0,1]
    v_pk_add_f32 v[138:139], v[150:151], v[156:157]
    v_pk_add_f32 v[140:141], v[148:149], v[158:159]
    v_pk_add_f32 v[142:143], v[150:151], v[156:157] neg_lo:[0,1] neg_hi:[0,1]
    v_cvt_pk_bf16_f32 v7, v140, v141
    buffer_load_dwordx4 v0, s[56:59], s68 offen offset:2048 lds
    v_cvt_pk_bf16_f32 v9, v142, v143
    v_cvt_pk_bf16_f32 v6, v136, v137
    v_cvt_pk_bf16_f32 v8, v138, v139
    ds_write_b64 v60, v[2:3] offset:0
    ds_write_b64 v60, v[4:5] offset:2048
    ds_write_b64 v60, v[6:7] offset:4096
    ds_write_b64 v60, v[8:9] offset:6144
    ds_write_b32 v60, v22 offset:8192
    ds_write_b32 v60, v23 offset:10240
    s_waitcnt lgkmcnt(0)
    s_barrier
    buffer_load_dwordx4 v0, s[56:59], s68 offen offset:3072 lds
    ds_read_b64_tr_b16 v[128:129], v61 offset:0
    ds_read_b64_tr_b16 v[130:131], v61 offset:512
    ds_read_b64_tr_b16 v[132:133], v61 offset:1024
    ds_read_b64_tr_b16 v[134:135], v61 offset:1536
    ds_read_b64_tr_b16 v[136:137], v61 offset:2048
    ds_read_b64_tr_b16 v[138:139], v61 offset:2560
    ds_read_b64_tr_b16 v[140:141], v61 offset:3072
    ds_read_b64_tr_b16 v[142:143], v61 offset:3584
    ds_read_b64_tr_b16 v[144:145], v61 offset:4096
    ds_read_b64_tr_b16 v[146:147], v61 offset:4608
    s_add_u32 s68, s68, 20480
    s_add_u32 s70, s70, 20480
    s_mov_b32 m0, s70
    s_nop 0
    buffer_load_dwordx4 v0, s[56:59], s68 offen offset:0 lds
    ds_read_b64_tr_b16 v[148:149], v61 offset:5120
    ds_read_b64_tr_b16 v[150:151], v61 offset:5632
    ds_read_b64_tr_b16 v[152:153], v61 offset:6144
    ds_read_b64_tr_b16 v[154:155], v61 offset:6656
    ds_read_b64_tr_b16 v[156:157], v61 offset:7168
    ds_read_b64_tr_b16 v[158:159], v61 offset:7680
    ds_read_b64_tr_b16 v[160:161], v61 offset:8192
    ds_read_b64_tr_b16 v[162:163], v61 offset:8704
    ds_read_b64_tr_b16 v[164:165], v61 offset:9216
    ds_read_b64_tr_b16 v[166:167], v61 offset:9728
    buffer_load_dwordx4 v0, s[56:59], s68 offen offset:1024 lds
    ds_read_b64_tr_b16 v[168:169], v61 offset:10240
    ds_read_b64_tr_b16 v[170:171], v61 offset:10752
    ds_read_b64_tr_b16 v[172:173], v61 offset:11264
    ds_read_b64_tr_b16 v[174:175], v61 offset:11776
    s_waitcnt lgkmcnt(15)
    v_mfma_f32_16x16x32_bf16 v[24:27], v[128:131], v[64:67], 0
    v_mfma_f32_16x16x32_bf16 v[28:31], v[128:131], v[72:75], 0
    s_waitcnt lgkmcnt(15)
    v_mfma_f32_16x16x32_bf16 v[24:27], v[132:135], v[68:71], v[24:27]
    v_mfma_f32_16x16x32_bf16 v[28:31], v[132:135], v[76:79], v[28:31]
    buffer_load_dwordx4 v0, s[56:59], s68 offen offset:2048 lds
    s_waitcnt lgkmcnt(15)
    v_mfma_f32_16x16x32_bf16 v[24:27], v[136:139], v[80:83], v[24:27]
    v_mfma_f32_16x16x32_bf16 v[28:31], v[136:139], v[88:91], v[28:31]
    s_waitcnt lgkmcnt(15)
    v_mfma_f32_16x16x32_bf16 v[24:27], v[140:143], v[84:87], v[24:27]
    v_mfma_f32_16x16x32_bf16 v[28:31], v[140:143], v[92:95], v[28:31]
    s_waitcnt lgkmcnt(14)
    v_mfma_f32_16x16x32_bf16 v[32:35], v[144:147], v[64:67], 0
    v_mfma_f32_16x16x32_bf16 v[36:39], v[144:147], v[72:75], 0
    s_waitcnt lgkmcnt(12)
    v_mfma_f32_16x16x32_bf16 v[32:35], v[148:151], v[68:71], v[32:35]
    buffer_load_dwordx4 v0, s[56:59], s68 offen offset:3072 lds
    v_mfma_f32_16x16x32_bf16 v[36:39], v[148:151], v[76:79], v[36:39]
    s_waitcnt lgkmcnt(10)
    v_mfma_f32_16x16x32_bf16 v[32:35], v[152:155], v[80:83], v[32:35]
    v_mfma_f32_16x16x32_bf16 v[36:39], v[152:155], v[88:91], v[36:39]
    s_waitcnt lgkmcnt(8)
    v_mfma_f32_16x16x32_bf16 v[32:35], v[156:159], v[84:87], v[32:35]
    v_mfma_f32_16x16x32_bf16 v[36:39], v[156:159], v[92:95], v[36:39]
    s_waitcnt lgkmcnt(6)
    v_mfma_f32_16x16x32_bf16 v[40:43], v[160:163], v[64:67], 0
    v_mfma_f32_16x16x32_bf16 v[44:47], v[160:163], v[72:75], 0
    s_add_u32 s68, s68, 20480
    s_add_u32 s70, s70, 20480
    s_mov_b32 m0, s70
    s_nop 0
    buffer_load_dwordx4 v0, s[56:59], s68 offen offset:0 lds
    s_waitcnt lgkmcnt(4)
    v_mfma_f32_16x16x32_bf16 v[40:43], v[164:167], v[68:71], v[40:43]
    v_mfma_f32_16x16x32_bf16 v[44:47], v[164:167], v[76:79], v[44:47]
    s_waitcnt lgkmcnt(2)
    v_mfma_f32_16x16x32_bf16 v[40:43], v[168:171], v[80:83], v[40:43]
    v_mfma_f32_16x16x32_bf16 v[44:47], v[168:171], v[88:91], v[44:47]
    s_waitcnt lgkmcnt(0)
    s_barrier
    v_mfma_f32_16x16x32_bf16 v[40:43], v[172:175], v[84:87], v[40:43]
    v_mfma_f32_16x16x32_bf16 v[44:47], v[172:175], v[92:95], v[44:47]
    buffer_load_dwordx4 v0, s[56:59], s68 offen offset:1024 lds
    v_cvt_pk_bf16_f32 v2, v24, v25
    ds_write_b32 v106, v2
    v_cvt_pk_bf16_f32 v7, v28, v29
    ds_write_b32 v111, v7
    v_cvt_pk_bf16_f32 v3, v26, v27
    ds_write_b32 v107, v3
    v_cvt_pk_bf16_f32 v8, v30, v31
    ds_write_b32 v112, v8
    v_cvt_pk_bf16_f32 v4, v32, v33
    ds_write_b32 v108, v4
    buffer_load_dwordx4 v0, s[56:59], s68 offen offset:2048 lds
    v_cvt_pk_bf16_f32 v9, v36, v37
    ds_write_b32 v113, v9
    v_cvt_pk_bf16_f32 v5, v34, v35
    ds_write_b32 v109, v5
    v_cvt_pk_bf16_f32 v10, v38, v39
    ds_write_b32 v114, v10
    v_cvt_pk_bf16_f32 v6, v40, v41
    ds_write_b32 v110, v6
    v_cvt_pk_bf16_f32 v11, v44, v45
    ds_write_b32 v115, v11
    buffer_load_dwordx4 v0, s[56:59], s68 offen offset:3072 lds
    s_waitcnt lgkmcnt(0)
    s_barrier
    ds_read_b128 v[24:27], v62 offset:0
    ds_read_b128 v[28:31], v62 offset:512
    ds_read_b128 v[32:35], v62 offset:1024
    ds_read_b128 v[36:39], v62 offset:1536
    ds_read_b128 v[40:43], v62 offset:2048
    s_waitcnt lgkmcnt(4)
    v_perm_b32 v24, v24, v24, v63
    v_perm_b32 v25, v25, v25, v63
    buffer_load_dwordx4 a[0:3], v0, s[56:59], s69 offen offset:0
    v_perm_b32 v26, v26, v26, v63
    v_perm_b32 v27, v27, v27, v63
    v_pk_add_f32 v[24:25], v[24:25], v[176:177]
    v_pk_add_f32 v[26:27], v[26:27], v[178:179]
    v_cvt_pk_bf16_f32 v2, v24, v25
    v_cvt_pk_bf16_f32 v3, v26, v27
    s_waitcnt lgkmcnt(3)
    v_perm_b32 v28, v28, v28, v63
    v_perm_b32 v29, v29, v29, v63
    v_perm_b32 v30, v30, v30, v63
    buffer_load_dwordx4 a[4:7], v0, s[56:59], s69 offen offset:1024
    v_perm_b32 v31, v31, v31, v63
    v_pk_add_f32 v[28:29], v[28:29], v[180:181]
    v_pk_add_f32 v[30:31], v[30:31], v[182:183]
    v_cvt_pk_bf16_f32 v4, v28, v29
    v_cvt_pk_bf16_f32 v5, v30, v31
    s_waitcnt lgkmcnt(2)
    v_perm_b32 v32, v32, v32, v63
    v_perm_b32 v33, v33, v33, v63
    v_perm_b32 v34, v34, v34, v63
    v_perm_b32 v35, v35, v35, v63
    buffer_load_dwordx4 a[8:11], v0, s[56:59], s69 offen offset:2048
    v_pk_add_f32 v[32:33], v[32:33], v[184:185]
    v_pk_add_f32 v[34:35], v[34:35], v[186:187]
    v_cvt_pk_bf16_f32 v6, v32, v33
    v_cvt_pk_bf16_f32 v7, v34, v35
    s_waitcnt lgkmcnt(1)
    v_perm_b32 v36, v36, v36, v63
    v_perm_b32 v37, v37, v37, v63
    v_perm_b32 v38, v38, v38, v63
    v_perm_b32 v39, v39, v39, v63
    v_pk_add_f32 v[36:37], v[36:37], v[188:189]
    buffer_load_dwordx4 a[12:15], v0, s[56:59], s69 offen offset:3072
    s_add_u32 s69, s69, 4096
    v_pk_add_f32 v[38:39], v[38:39], v[190:191]
    v_cvt_pk_bf16_f32 v8, v36, v37
    v_cvt_pk_bf16_f32 v9, v38, v39
    s_waitcnt lgkmcnt(0)
    v_perm_b32 v40, v40, v40, v63
    v_perm_b32 v41, v41, v41, v63
    v_perm_b32 v42, v42, v42, v63
    v_perm_b32 v43, v43, v43, v63
    v_pk_add_f32 v[40:41], v[40:41], v[192:193]
    v_pk_add_f32 v[42:43], v[42:43], v[194:195]
    buffer_load_dwordx4 a[16:19], v0, s[56:59], s69 offen offset:0
    v_cvt_pk_bf16_f32 v10, v40, v41
    v_cvt_pk_bf16_f32 v11, v42, v43
    v_lshlrev_b32 v24, 16, v2
    v_and_b32 v25, 0xffff0000, v2
    v_lshlrev_b32 v26, 16, v3
    v_and_b32 v27, 0xffff0000, v3
    v_lshlrev_b32 v28, 16, v4
    v_and_b32 v29, 0xffff0000, v4
    v_lshlrev_b32 v30, 16, v5
    v_and_b32 v31, 0xffff0000, v5
    buffer_load_dwordx4 a[20:23], v0, s[56:59], s69 offen offset:1024
    v_lshlrev_b32 v32, 16, v6
    v_and_b32 v33, 0xffff0000, v6
    v_lshlrev_b32 v34, 16, v7
    v_and_b32 v35, 0xffff0000, v7
    v_lshlrev_b32 v36, 16, v8
    v_and_b32 v37, 0xffff0000, v8
    v_lshlrev_b32 v38, 16, v9
    v_and_b32 v39, 0xffff0000, v9
    v_lshlrev_b32 v40, 16, v10
    v_and_b32 v41, 0xffff0000, v10
    buffer_load_dwordx4 a[24:27], v0, s[56:59], s69 offen offset:2048
    v_lshlrev_b32 v42, 16, v11
    v_and_b32 v43, 0xffff0000, v11
    v_pk_add_f32 v[96:97], v[24:25], v[26:27]
    v_pk_add_f32 v[98:99], v[28:29], v[30:31]
    v_pk_add_f32 v[96:97], v[96:97], v[32:33]
    v_pk_add_f32 v[98:99], v[98:99], v[34:35]
    v_pk_add_f32 v[96:97], v[96:97], v[36:37]
    v_pk_add_f32 v[98:99], v[98:99], v[38:39]
    v_pk_add_f32 v[96:97], v[96:97], v[40:41]
    v_pk_add_f32 v[98:99], v[98:99], v[42:43]
    buffer_load_dwordx4 a[28:31], v0, s[56:59], s69 offen offset:3072
    s_add_u32 s69, s69, 4096
    v_pk_add_f32 v[96:97], v[96:97], v[98:99]
    v_add_f32 v100, v96, v97
    s_nop 1
    v_add_f32_dpp v100, v100, v100 quad_perm:[1,0,3,2] row_mask:0xf bank_mask:0xf
    s_nop 1
    v_add_f32_dpp v100, v100, v100 quad_perm:[2,3,0,1] row_mask:0xf bank_mask:0xf
    s_nop 1
    v_add_f32_dpp v100, v100, v100 row_half_mirror row_mask:0xf bank_mask:0xf
    s_nop 1
    v_add_f32_dpp v100, v100, v100 row_mirror row_mask:0xf bank_mask:0xf
    v_mov_b32 v98, v100
    s_nop 1
    v_permlane16_swap_b32 v100, v98
    v_add_f32 v100, v100, v98
    v_mul_f32 v100, 0x3acccccd, v100
    v_pk_add_f32 v[64:65], v[24:25], v[100:101] op_sel_hi:[1,0] neg_lo:[0,1] neg_hi:[0,1]
    v_pk_add_f32 v[66:67], v[26:27], v[100:101] op_sel_hi:[1,0] neg_lo:[0,1] neg_hi:[0,1]
    v_pk_add_f32 v[68:69], v[28:29], v[100:101] op_sel_hi:[1,0] neg_lo:[0,1] neg_hi:[0,1]
    v_pk_add_f32 v[70:71], v[30:31], v[100:101] op_sel_hi:[1,0] neg_lo:[0,1] neg_hi:[0,1]
    v_pk_add_f32 v[72:73], v[32:33], v[100:101] op_sel_hi:[1,0] neg_lo:[0,1] neg_hi:[0,1]
    v_pk_add_f32 v[74:75], v[34:35], v[100:101] op_sel_hi:[1,0] neg_lo:[0,1] neg_hi:[0,1]
    v_pk_add_f32 v[76:77], v[36:37], v[100:101] op_sel_hi:[1,0] neg_lo:[0,1] neg_hi:[0,1]
    v_pk_add_f32 v[78:79], v[38:39], v[100:101] op_sel_hi:[1,0] neg_lo:[0,1] neg_hi:[0,1]
    v_pk_add_f32 v[80:81], v[40:41], v[100:101] op_sel_hi:[1,0] neg_lo:[0,1] neg_hi:[0,1]
    v_pk_add_f32 v[82:83], v[42:43], v[100:101] op_sel_hi:[1,0] neg_lo:[0,1] neg_hi:[0,1]
    v_pk_mul_f32 v[96:97], v[64:65], v[64:65]
    v_pk_mul_f32 v[98:99], v[66:67], v[66:67]
    v_pk_fma_f32 v[96:97], v[68:69], v[68:69], v[96:97]
    v_pk_fma_f32 v[98:99], v[70:71], v[70:71], v[98:99]
    v_pk_fma_f32 v[96:97], v[72:73], v[72:73], v[96:97]
    v_pk_fma_f32 v[98:99], v[74:75], v[74:75], v[98:99]
    v_pk_fma_f32 v[96:97], v[76:77], v[76:77], v[96:97]
    v_pk_fma_f32 v[98:99], v[78:79], v[78:79], v[98:99]
    v_pk_fma_f32 v[96:97], v[80:81], v[80:81], v[96:97]
    v_pk_fma_f32 v[98:99], v[82:83], v[82:83], v[98:99]
    v_pk_add_f32 v[96:97], v[96:97], v[98:99]
    v_add_f32 v102, v96, v97
    s_nop 1
    v_add_f32_dpp v102, v102, v102 quad_perm:[1,0,3,2] row_mask:0xf bank_mask:0xf
    s_nop 1
    v_add_f32_dpp v102, v102, v102 quad_perm:[2,3,0,1] row_mask:0xf bank_mask:0xf
    s_nop 1
    v_add_f32_dpp v102, v102, v102 row_half_mirror row_mask:0xf bank_mask:0xf
    s_nop 1
    v_add_f32_dpp v102, v102, v102 row_mirror row_mask:0xf bank_mask:0xf
    v_mov_b32 v98, v102
    s_nop 1
    v_permlane16_swap_b32 v102, v98
    v_add_f32 v102, v102, v98
    v_mul_f32 v102, 0x3acccccd, v102
    v_cvt_pk_bf16_f32 v102, v102, v102
    v_lshlrev_b32 v102, 16, v102
    v_add_f32 v102, 0x3727c5ac, v102
    v_cvt_pk_bf16_f32 v102, v102, v102
    v_lshlrev_b32 v102, 16, v102
    v_sqrt_f32 v102, v102
    v_cvt_pk_bf16_f32 v100, v100, v100
    v_lshlrev_b32 v100, 16, v100
    v_cvt_pk_bf16_f32 v102, v102, v102
    v_lshlrev_b32 v102, 16, v102
    v_rcp_f32 v102, v102
    s_nop 0
    v_mul_f32 v104, v100, v102
    v_sub_f32 v104, 0, v104
    v_pk_fma_f32 v[24:25], v[24:25], v[102:103], v[104:105] op_sel_hi:[1,0,0]
    v_pk_fma_f32 v[26:27], v[26:27], v[102:103], v[104:105] op_sel_hi:[1,0,0]
    v_cvt_pk_bf16_f32 v12, v24, v25
    v_cvt_pk_bf16_f32 v13, v26, v27
    ds_write_b64 v127, v[12:13] offset:0
    v_pk_fma_f32 v[28:29], v[28:29], v[102:103], v[104:105] op_sel_hi:[1,0,0]
    v_pk_fma_f32 v[30:31], v[30:31], v[102:103], v[104:105] op_sel_hi:[1,0,0]
    v_cvt_pk_bf16_f32 v14, v28, v29
    v_cvt_pk_bf16_f32 v15, v30, v31
    ds_write_b64 v127, v[14:15] offset:512
    v_pk_fma_f32 v[32:33], v[32:33], v[102:103], v[104:105] op_sel_hi:[1,0,0]
    v_pk_fma_f32 v[34:35], v[34:35], v[102:103], v[104:105] op_sel_hi:[1,0,0]
    v_cvt_pk_bf16_f32 v16, v32, v33
    v_cvt_pk_bf16_f32 v17, v34, v35
    ds_write_b64 v127, v[16:17] offset:1024
    v_pk_fma_f32 v[36:37], v[36:37], v[102:103], v[104:105] op_sel_hi:[1,0,0]
    v_pk_fma_f32 v[38:39], v[38:39], v[102:103], v[104:105] op_sel_hi:[1,0,0]
    v_cvt_pk_bf16_f32 v18, v36, v37
    v_cvt_pk_bf16_f32 v19, v38, v39
    ds_write_b64 v127, v[18:19] offset:1536
    v_pk_fma_f32 v[40:41], v[40:41], v[102:103], v[104:105] op_sel_hi:[1,0,0]
    v_pk_fma_f32 v[42:43], v[42:43], v[102:103], v[104:105] op_sel_hi:[1,0,0]
    v_cvt_pk_bf16_f32 v20, v40, v41
    v_cvt_pk_bf16_f32 v21, v42, v43
    ds_write_b64 v127, v[20:21] offset:2048
    s_waitcnt lgkmcnt(0)
    s_barrier
    s_cmp_ge_u32 s20, 2
    s_cbranch_scc1 K3_dma
    ds_read_b128 v[24:27], v120 offset:0
    ds_read_b128 v[28:31], v120 offset:256
    ds_read_b128 v[32:35], v120 offset:512
    ds_read_b128 v[36:39], v120 offset:768
    ds_read_b128 v[40:43], v120 offset:1024
    s_waitcnt lgkmcnt(4)
    buffer_store_dwordx4 v[24:27], v119, s[32:35], s50 offen offset:0 sc1
    s_waitcnt lgkmcnt(3)
    buffer_store_dwordx4 v[28:31], v119, s[32:35], s50 offen offset:2048 sc1
    s_waitcnt lgkmcnt(2)
    buffer_store_dwordx4 v[32:35], v119, s[32:35], s51 offen offset:0 sc1
    s_waitcnt lgkmcnt(1)
    buffer_store_dwordx4 v[36:39], v119, s[32:35], s51 offen offset:2048 sc1
    s_waitcnt lgkmcnt(0)
    buffer_store_dwordx4 v[40:43], v119, s[32:35], s52 offen offset:0 sc1
    buffer_store_dwordx2 v[2:3], v126, s[28:31], s23 offen offset:0 sc1
    buffer_store_dwordx2 v[4:5], v126, s[28:31], s23 offen offset:256 sc1
    buffer_store_dwordx2 v[6:7], v126, s[28:31], s23 offen offset:512 sc1
    buffer_store_dwordx2 v[8:9], v126, s[28:31], s23 offen offset:768 sc1
    buffer_store_dwordx2 v[10:11], v126, s[28:31], s23 offen offset:1024 sc1
    v_lshlrev_b32 v120, 16, v232
    v_and_b32 v121, 0xffff0000, v232
    v_lshlrev_b32 v122, 16, v233
    v_and_b32 v123, 0xffff0000, v233
    v_lshlrev_b32 v124, 16, v234
    v_and_b32 v125, 0xffff0000, v234
    v_lshlrev_b32 v126, 16, v235
    v_and_b32 v127, 0xffff0000, v235
    v_lshlrev_b32 v128, 16, v236
    v_and_b32 v129, 0xffff0000, v236
    v_lshlrev_b32 v130, 16, v237
    v_and_b32 v131, 0xffff0000, v237
    v_lshlrev_b32 v132, 16, v238
    v_and_b32 v133, 0xffff0000, v238
    v_lshlrev_b32 v134, 16, v239
    v_and_b32 v135, 0xffff0000, v239
    v_lshlrev_b32 v136, 16, v240
    v_and_b32 v137, 0xffff0000, v240
    v_lshlrev_b32 v138, 16, v241
    v_and_b32 v139, 0xffff0000, v241
    v_lshlrev_b32 v140, 16, v242
    v_and_b32 v141, 0xffff0000, v242
    v_lshlrev_b32 v142, 16, v243
    v_and_b32 v143, 0xffff0000, v243
    v_lshlrev_b32 v144, 16, v244
    v_and_b32 v145, 0xffff0000, v244
    v_lshlrev_b32 v146, 16, v245
    v_and_b32 v147, 0xffff0000, v245
    s_mov_b32 s12, s60
    s_mov_b32 s13, s61
    s_mov_b32 s14, 1280
    s_mov_b32 s15, 0x20000
    s_and_b32 s24, s98, 7
    s_mul_i32 s24, s24, 160
    s_mul_i32 s50, s20, 21120
    s_movk_i32 s51, 0x500
    v_add_u32 v5, 0, v1
    v_mul_u32_u24 v6, 6554, v5
    v_lshrrev_b32 v6, 16, v6
    v_mul_u32_u24 v7, 10, v6
    v_sub_u32 v5, v5, v7
    v_lshlrev_b32 v7, 4, v5
    v_mad_u32_u24 v196, v6, s51, v7
    buffer_load_dwordx4 v[208:211], v7, s[12:15], s24 offen
    v_mul_u32_u24 v5, 528, v5
    v_lshl_add_u32 v5, v6, 4, v5
    v_add_u32 v199, s50, v5
    v_add_u32 v5, 64, v1
    v_mul_u32_u24 v6, 6554, v5
    v_lshrrev_b32 v6, 16, v6
    v_mul_u32_u24 v7, 10, v6
    v_sub_u32 v5, v5, v7
    v_lshlrev_b32 v7, 4, v5
    v_mad_u32_u24 v197, v6, s51, v7
    buffer_load_dwordx4 v[212:215], v7, s[12:15], s24 offen
    v_mul_u32_u24 v5, 528, v5
    v_lshl_add_u32 v5, v6, 4, v5
    v_add_u32 v200, s50, v5
    v_add_u32 v5, 128, v1
    v_mul_u32_u24 v6, 6554, v5
    v_lshrrev_b32 v6, 16, v6
    v_mul_u32_u24 v7, 10, v6
    v_sub_u32 v5, v5, v7
    v_lshlrev_b32 v7, 4, v5
    v_mad_u32_u24 v198, v6, s51, v7
    buffer_load_dwordx4 v[216:219], v7, s[12:15], s24 offen
    v_mul_u32_u24 v5, 528, v5
    v_lshl_add_u32 v5, v6, 4, v5
    v_add_u32 v201, s50, v5
    s_lshr_b32 s23, s3, 4
    s_lshl_b32 s23, s23, 3
    s_lshl_b32 s25, s20, 1
    s_add_u32 s23, s23, s25
    s_mul_i32 s26, s23, 20480
    v_add_u32 v6, 0x5000, v0
    s_add_u32 s36, s18, 17956864
    s_addc_u32 s37, s19, 0
    s_mov_b32 s38, 7340032
    s_mov_b32 s39, 0x20000
    v_add_u32 v229, 61440, v0
    v_add_u32 v230, 122880, v0
    s_mul_i32 s29, s23, 57344
    s_and_b32 s30, s3, 15
    s_lshr_b32 s31, s30, 1
    s_mul_i32 s31, s31, 7168
    s_add_u32 s29, s29, s31
    s_and_b32 s30, s30, 1
    s_mul_i32 s31, s30, 3072
    s_add_u32 s40, s29, s31
    s_lshl_b32 s31, s30, 9
    s_add_u32 s41, s29, s31
    s_add_u32 s41, s41, 6144
    v_add_u32 v4, 57344, v0
    v_bfe_u32 v5, v1, 4, 1
    v_mul_u32_u24 v5, 57344, v5
    v_and_b32 v2, 15, v1
    v_lshl_add_u32 v5, v2, 4, v5
    v_lshrrev_b32 v2, 5, v1
    v_lshl_add_u32 v5, v2, 8, v5
    s_lshl_b32 s21, s73, 6
    s_lshl_b32 s22, s20, 2
    s_add_u32 s21, s21, s22
    s_add_u32 s21, s21, 8192
    s_waitcnt vmcnt(8)
    s_mov_b64 exec, 1
    buffer_store_dword v6, v0, s[64:67], s21 offen sc0 sc1
    s_mov_b64 exec, -1
    s_branch K3_done
K3_dma:
    buffer_store_dwordx2 v[2:3], v126, s[28:31], s23 offen offset:0 sc1
    buffer_store_dwordx2 v[4:5], v126, s[28:31], s23 offen offset:256 sc1
    buffer_store_dwordx2 v[6:7], v126, s[28:31], s23 offen offset:512 sc1
    buffer_store_dwordx2 v[8:9], v126, s[28:31], s23 offen offset:768 sc1
    buffer_store_dwordx2 v[10:11], v126, s[28:31], s23 offen offset:1024 sc1
    s_lshr_b32 s70, s3, 4
    s_add_u32 s70, s70, s20
    s_and_b32 s70, s70, 1
    s_mul_i32 s70, s70, 2048
    s_add_u32 s70, s70, 16384
    s_mul_i32 s68, s74, 20480
    s_add_u32 s68, s68, s70
    s_mov_b32 m0, s70
    s_nop 0
    buffer_load_dwordx4 v0, s[56:59], s68 offen offset:0 lds
    buffer_load_dwordx4 v0, s[56:59], s68 offen offset:1024 lds
    s_add_u32 s68, s68, 20480
    s_add_u32 s70, s70, 20480
    s_mov_b32 m0, s70
    s_nop 0
    buffer_load_dwordx4 v0, s[56:59], s68 offen offset:0 lds
    buffer_load_dwordx4 v0, s[56:59], s68 offen offset:1024 lds
    s_add_u32 s68, s68, 20480
    s_add_u32 s70, s70, 20480
    s_mov_b32 m0, s70
    s_nop 0
    buffer_load_dwordx4 v0, s[56:59], s68 offen offset:0 lds
    buffer_load_dwordx4 v0, s[56:59], s68 offen offset:1024 lds
    s_add_u32 s68, s68, 20480
    s_add_u32 s70, s70, 20480
    s_mov_b32 m0, s70
    s_nop 0
    buffer_load_dwordx4 v0, s[56:59], s68 offen offset:0 lds
    buffer_load_dwordx4 v0, s[56:59], s68 offen offset:1024 lds
    s_add_u32 s68, s68, 20480
    s_add_u32 s70, s70, 20480
    s_mov_b32 m0, s70
    s_nop 0
    buffer_load_dwordx4 v0, s[56:59], s68 offen offset:0 lds
    buffer_load_dwordx4 v0, s[56:59], s68 offen offset:1024 lds
    s_add_u32 s68, s68, 20480
    s_add_u32 s70, s70, 20480
    s_mov_b32 m0, s70
    s_nop 0
    buffer_load_dwordx4 v0, s[56:59], s68 offen offset:0 lds
    buffer_load_dwordx4 v0, s[56:59], s68 offen offset:1024 lds
    s_add_u32 s68, s68, 20480
    s_add_u32 s70, s70, 20480
    s_mov_b32 m0, s70
    s_nop 0
    buffer_load_dwordx4 v0, s[56:59], s68 offen offset:0 lds
    buffer_load_dwordx4 v0, s[56:59], s68 offen offset:1024 lds
    v_lshlrev_b32 v120, 16, v232
    v_and_b32 v121, 0xffff0000, v232
    v_lshlrev_b32 v122, 16, v233
    v_and_b32 v123, 0xffff0000, v233
    v_lshlrev_b32 v124, 16, v234
    v_and_b32 v125, 0xffff0000, v234
    v_lshlrev_b32 v126, 16, v235
    v_and_b32 v127, 0xffff0000, v235
    v_lshlrev_b32 v128, 16, v236
    v_and_b32 v129, 0xffff0000, v236
    v_lshlrev_b32 v130, 16, v237
    v_and_b32 v131, 0xffff0000, v237
    v_lshlrev_b32 v132, 16, v238
    v_and_b32 v133, 0xffff0000, v238
    v_lshlrev_b32 v134, 16, v239
    v_and_b32 v135, 0xffff0000, v239
    v_lshlrev_b32 v136, 16, v240
    v_and_b32 v137, 0xffff0000, v240
    v_lshlrev_b32 v138, 16, v241
    v_and_b32 v139, 0xffff0000, v241
    v_lshlrev_b32 v140, 16, v242
    v_and_b32 v141, 0xffff0000, v242
    v_lshlrev_b32 v142, 16, v243
    v_and_b32 v143, 0xffff0000, v243
    v_lshlrev_b32 v144, 16, v244
    v_and_b32 v145, 0xffff0000, v244
    v_lshlrev_b32 v146, 16, v245
    v_and_b32 v147, 0xffff0000, v245
    s_mov_b32 s12, s60
    s_mov_b32 s13, s61
    s_mov_b32 s14, 1280
    s_mov_b32 s15, 0x20000
    s_and_b32 s24, s98, 7
    s_mul_i32 s24, s24, 160
    s_mul_i32 s50, s20, 21120
    s_movk_i32 s51, 0x500
    v_add_u32 v5, 0, v1
    v_mul_u32_u24 v6, 6554, v5
    v_lshrrev_b32 v6, 16, v6
    v_mul_u32_u24 v7, 10, v6
    v_sub_u32 v5, v5, v7
    v_lshlrev_b32 v7, 4, v5
    v_mad_u32_u24 v196, v6, s51, v7
    buffer_load_dwordx4 v[208:211], v7, s[12:15], s24 offen
    v_mul_u32_u24 v5, 528, v5
    v_lshl_add_u32 v5, v6, 4, v5
    v_add_u32 v199, s50, v5
    v_add_u32 v5, 64, v1
    v_mul_u32_u24 v6, 6554, v5
    v_lshrrev_b32 v6, 16, v6
    v_mul_u32_u24 v7, 10, v6
    v_sub_u32 v5, v5, v7
    v_lshlrev_b32 v7, 4, v5
    v_mad_u32_u24 v197, v6, s51, v7
    buffer_load_dwordx4 v[212:215], v7, s[12:15], s24 offen
    v_mul_u32_u24 v5, 528, v5
    v_lshl_add_u32 v5, v6, 4, v5
    v_add_u32 v200, s50, v5
    v_add_u32 v5, 128, v1
    v_mul_u32_u24 v6, 6554, v5
    v_lshrrev_b32 v6, 16, v6
    v_mul_u32_u24 v7, 10, v6
    v_sub_u32 v5, v5, v7
    v_lshlrev_b32 v7, 4, v5
    v_mad_u32_u24 v198, v6, s51, v7
    buffer_load_dwordx4 v[216:219], v7, s[12:15], s24 offen
    v_mul_u32_u24 v5, 528, v5
    v_lshl_add_u32 v5, v6, 4, v5
    v_add_u32 v201, s50, v5
    s_lshr_b32 s23, s3, 4
    s_lshl_b32 s23, s23, 3
    s_lshl_b32 s25, s20, 1
    s_add_u32 s23, s23, s25
    s_mul_i32 s26, s23, 20480
    v_add_u32 v6, 0x5000, v0
    s_add_u32 s36, s18, 17956864
    s_addc_u32 s37, s19, 0
    s_mov_b32 s38, 7340032
    s_mov_b32 s39, 0x20000
    v_add_u32 v229, 61440, v0
    v_add_u32 v230, 122880, v0
    s_mul_i32 s29, s23, 57344
    s_and_b32 s30, s3, 15
    s_lshr_b32 s31, s30, 1
    s_mul_i32 s31, s31, 7168
    s_add_u32 s29, s29, s31
    s_and_b32 s30, s30, 1
    s_mul_i32 s31, s30, 3072
    s_add_u32 s40, s29, s31
    s_lshl_b32 s31, s30, 9
    s_add_u32 s41, s29, s31
    s_add_u32 s41, s41, 6144
    v_add_u32 v4, 57344, v0
    v_bfe_u32 v5, v1, 4, 1
    v_mul_u32_u24 v5, 57344, v5
    v_and_b32 v2, 15, v1
    v_lshl_add_u32 v5, v2, 4, v5
    v_lshrrev_b32 v2, 5, v1
    v_lshl_add_u32 v5, v2, 8, v5
    s_waitcnt vmcnt(22)
K3_done:
    s_and_b32 s21, s3, 0xf0
    s_lshl_b32 s21, s21, 6
    s_add_u32 s21, s21, 8192
    s_cmp_lg_u32 s20, 1
    s_cbranch_scc1 KF_pd2
    v_lshlrev_b32 v224, 6, v1
    s_mov_b64 exec, 0xffff
    s_mov_b32 s72, 32768
KF_pl2:
    buffer_load_dwordx2 v[220:221], v224, s[64:67], s21 offen sc0 sc1
    s_waitcnt vmcnt(0)
    v_min_u32 v220, v220, v221
    v_cmp_eq_u32 vcc, 0, v220
    s_sub_u32 s72, s72, 1
    s_nop 2
    s_cbranch_scc1 KF_pe2
    s_cbranch_vccz KF_pe2
    s_mov_b64 exec, vcc
    s_branch KF_pl2
KF_pe2:
    s_mov_b64 exec, -1
KF_pd2:
    s_barrier
    buffer_load_dwordx4 v[148:151], v0, s[32:35], s26 offen offset:0
    buffer_load_dwordx4 v[152:155], v6, s[32:35], s26 offen offset:0
    buffer_load_dwordx4 v[156:159], v0, s[32:35], s26 offen offset:1024
    buffer_load_dwordx4 v[160:163], v6, s[32:35], s26 offen offset:1024
    buffer_load_dwordx4 v[164:167], v0, s[32:35], s26 offen offset:2048
    buffer_load_dwordx4 v[168:171], v6, s[32:35], s26 offen offset:2048
    buffer_load_dwordx4 v[172:175], v0, s[32:35], s26 offen offset:3072
    buffer_load_dwordx4 v[176:179], v6, s[32:35], s26 offen offset:3072
    s_add_u32 s26, s26, 4096
    buffer_load_dwordx4 v[180:183], v0, s[32:35], s26 offen offset:0
    buffer_load_dwordx4 v[184:187], v6, s[32:35], s26 offen offset:0
    buffer_load_dwordx4 v[188:191], v0, s[32:35], s26 offen offset:1024
    buffer_load_dwordx4 v[192:195], v6, s[32:35], s26 offen offset:1024
    ds_read_b128 v[64:67], v0 offset:0
    ds_read_b128 v[68:71], v0 offset:20480
    ds_read_b128 v[72:75], v0 offset:40960
    ds_read_b128 v[76:79], v229 offset:0
    ds_read_b128 v[80:83], v229 offset:20480
    ds_read_b128 v[84:87], v229 offset:40960
    ds_read_b128 v[88:91], v230 offset:0
    s_waitcnt vmcnt(10) lgkmcnt(0)
    v_mfma_f32_16x16x32_bf16 v[8:11], v[64:67], v[148:151], v[120:123]
    ds_read_b128 v[92:95], v0 offset:1024
    v_mfma_f32_16x16x32_bf16 v[36:39], v[64:67], v[152:155], v[120:123]
    ds_read_b128 v[96:99], v0 offset:21504
    v_mfma_f32_16x16x32_bf16 v[12:15], v[68:71], v[148:151], v[124:127]
    ds_read_b128 v[100:103], v0 offset:41984
    v_mfma_f32_16x16x32_bf16 v[40:43], v[68:71], v[152:155], v[124:127]
    ds_read_b128 v[104:107], v229 offset:1024
    v_mfma_f32_16x16x32_bf16 v[16:19], v[72:75], v[148:151], v[128:131]
    ds_read_b128 v[108:111], v229 offset:21504
    v_mfma_f32_16x16x32_bf16 v[44:47], v[72:75], v[152:155], v[128:131]
    ds_read_b128 v[112:115], v229 offset:41984
    buffer_load_dwordx4 a[32:35], v0, s[56:59], s69 offen offset:0
    v_mfma_f32_16x16x32_bf16 v[20:23], v[76:79], v[148:151], v[132:135]
    ds_read_b128 v[116:119], v230 offset:1024
    v_mfma_f32_16x16x32_bf16 v[48:51], v[76:79], v[152:155], v[132:135]
    v_mfma_f32_16x16x32_bf16 v[24:27], v[80:83], v[148:151], v[136:139]
    buffer_load_dwordx4 a[36:39], v0, s[56:59], s69 offen offset:1024
    v_mfma_f32_16x16x32_bf16 v[52:55], v[80:83], v[152:155], v[136:139]
    v_mfma_f32_16x16x32_bf16 v[28:31], v[84:87], v[148:151], v[140:143]
    v_mfma_f32_16x16x32_bf16 v[56:59], v[84:87], v[152:155], v[140:143]
    buffer_load_dwordx4 a[40:43], v0, s[56:59], s69 offen offset:2048
    v_mfma_f32_16x16x32_bf16 v[32:35], v[88:91], v[148:151], v[144:147]
    v_mfma_f32_16x16x32_bf16 v[60:63], v[88:91], v[152:155], v[144:147]
    buffer_load_dwordx4 v[148:151], v0, s[32:35], s26 offen offset:2048
    buffer_load_dwordx4 v[152:155], v6, s[32:35], s26 offen offset:2048
    s_waitcnt vmcnt(13) lgkmcnt(0)
    v_mfma_f32_16x16x32_bf16 v[8:11], v[92:95], v[156:159], v[8:11]
    ds_read_b128 v[64:67], v0 offset:2048
    v_mfma_f32_16x16x32_bf16 v[36:39], v[92:95], v[160:163], v[36:39]
    ds_read_b128 v[68:71], v0 offset:22528
    v_mfma_f32_16x16x32_bf16 v[12:15], v[96:99], v[156:159], v[12:15]
    ds_read_b128 v[72:75], v0 offset:43008
    v_mfma_f32_16x16x32_bf16 v[40:43], v[96:99], v[160:163], v[40:43]
    ds_read_b128 v[76:79], v229 offset:2048
    v_mfma_f32_16x16x32_bf16 v[16:19], v[100:103], v[156:159], v[16:19]
    ds_read_b128 v[80:83], v229 offset:22528
    v_mfma_f32_16x16x32_bf16 v[44:47], v[100:103], v[160:163], v[44:47]
    ds_read_b128 v[84:87], v229 offset:43008
    buffer_load_dwordx4 a[44:47], v0, s[56:59], s69 offen offset:3072
    s_add_u32 s69, s69, 4096
    v_mfma_f32_16x16x32_bf16 v[20:23], v[104:107], v[156:159], v[20:23]
    ds_read_b128 v[88:91], v230 offset:2048
    v_mfma_f32_16x16x32_bf16 v[48:51], v[104:107], v[160:163], v[48:51]
    v_mfma_f32_16x16x32_bf16 v[24:27], v[108:111], v[156:159], v[24:27]
    buffer_load_dwordx4 a[48:51], v0, s[56:59], s69 offen offset:0
    v_mfma_f32_16x16x32_bf16 v[52:55], v[108:111], v[160:163], v[52:55]
    v_mfma_f32_16x16x32_bf16 v[28:31], v[112:115], v[156:159], v[28:31]
    v_mfma_f32_16x16x32_bf16 v[56:59], v[112:115], v[160:163], v[56:59]
    buffer_load_dwordx4 a[52:55], v0, s[56:59], s69 offen offset:1024
    v_mfma_f32_16x16x32_bf16 v[32:35], v[116:119], v[156:159], v[32:35]
    v_mfma_f32_16x16x32_bf16 v[60:63], v[116:119], v[160:163], v[60:63]
    buffer_load_dwordx4 v[156:159], v0, s[32:35], s26 offen offset:3072
    buffer_load_dwordx4 v[160:163], v6, s[32:35], s26 offen offset:3072
    s_add_u32 s26, s26, 4096
    s_waitcnt vmcnt(16) lgkmcnt(0)
    v_mfma_f32_16x16x32_bf16 v[8:11], v[64:67], v[164:167], v[8:11]
    ds_read_b128 v[92:95], v0 offset:3072
    v_mfma_f32_16x16x32_bf16 v[36:39], v[64:67], v[168:171], v[36:39]
    ds_read_b128 v[96:99], v0 offset:23552
    v_mfma_f32_16x16x32_bf16 v[12:15], v[68:71], v[164:167], v[12:15]
    ds_read_b128 v[100:103], v0 offset:44032
    v_mfma_f32_16x16x32_bf16 v[40:43], v[68:71], v[168:171], v[40:43]
    ds_read_b128 v[104:107], v229 offset:3072
    v_mfma_f32_16x16x32_bf16 v[16:19], v[72:75], v[164:167], v[16:19]
    ds_read_b128 v[108:111], v229 offset:23552
    v_mfma_f32_16x16x32_bf16 v[44:47], v[72:75], v[168:171], v[44:47]
    ds_read_b128 v[112:115], v229 offset:44032
    v_mfma_f32_16x16x32_bf16 v[20:23], v[76:79], v[164:167], v[20:23]
    ds_read_b128 v[116:119], v230 offset:3072
    v_mfma_f32_16x16x32_bf16 v[48:51], v[76:79], v[168:171], v[48:51]
    v_mfma_f32_16x16x32_bf16 v[24:27], v[80:83], v[164:167], v[24:27]
    buffer_load_dwordx4 a[56:59], v0, s[56:59], s69 offen offset:2048
    v_mfma_f32_16x16x32_bf16 v[52:55], v[80:83], v[168:171], v[52:55]
    v_mfma_f32_16x16x32_bf16 v[28:31], v[84:87], v[164:167], v[28:31]
    v_mfma_f32_16x16x32_bf16 v[56:59], v[84:87], v[168:171], v[56:59]
    buffer_load_dwordx4 a[60:63], v0, s[56:59], s69 offen offset:3072
    s_add_u32 s69, s69, 4096
    v_mfma_f32_16x16x32_bf16 v[32:35], v[88:91], v[164:167], v[32:35]
    v_mfma_f32_16x16x32_bf16 v[60:63], v[88:91], v[168:171], v[60:63]
    buffer_load_dwordx4 v[164:167], v0, s[32:35], s26 offen offset:0
    buffer_load_dwordx4 v[168:171], v6, s[32:35], s26 offen offset:0
    s_waitcnt vmcnt(18) lgkmcnt(0)
    v_mfma_f32_16x16x32_bf16 v[8:11], v[92:95], v[172:175], v[8:11]
    ds_read_b128 v[64:67], v0 offset:4096
    v_mfma_f32_16x16x32_bf16 v[36:39], v[92:95], v[176:179], v[36:39]
    ds_read_b128 v[68:71], v0 offset:24576
    v_mfma_f32_16x16x32_bf16 v[12:15], v[96:99], v[172:175], v[12:15]
    ds_read_b128 v[72:75], v0 offset:45056
    v_mfma_f32_16x16x32_bf16 v[40:43], v[96:99], v[176:179], v[40:43]
    ds_read_b128 v[76:79], v229 offset:4096
    v_mfma_f32_16x16x32_bf16 v[16:19], v[100:103], v[172:175], v[16:19]
    ds_read_b128 v[80:83], v229 offset:24576
    v_mfma_f32_16x16x32_bf16 v[44:47], v[100:103], v[176:179], v[44:47]
    ds_read_b128 v[84:87], v229 offset:45056
    v_mfma_f32_16x16x32_bf16 v[20:23], v[104:107], v[172:175], v[20:23]
    ds_read_b128 v[88:91], v230 offset:4096
    v_mfma_f32_16x16x32_bf16 v[48:51], v[104:107], v[176:179], v[48:51]
    v_mfma_f32_16x16x32_bf16 v[24:27], v[108:111], v[172:175], v[24:27]
    buffer_load_dwordx4 a[64:67], v0, s[56:59], s69 offen offset:0
    v_mfma_f32_16x16x32_bf16 v[52:55], v[108:111], v[176:179], v[52:55]
    v_mfma_f32_16x16x32_bf16 v[28:31], v[112:115], v[172:175], v[28:31]
    v_mfma_f32_16x16x32_bf16 v[56:59], v[112:115], v[176:179], v[56:59]
    buffer_load_dwordx4 a[68:71], v0, s[56:59], s69 offen offset:1024
    v_mfma_f32_16x16x32_bf16 v[32:35], v[116:119], v[172:175], v[32:35]
    v_mfma_f32_16x16x32_bf16 v[60:63], v[116:119], v[176:179], v[60:63]
    buffer_load_dwordx4 v[172:175], v0, s[32:35], s26 offen offset:1024
    buffer_load_dwordx4 v[176:179], v6, s[32:35], s26 offen offset:1024
    s_waitcnt vmcnt(20) lgkmcnt(0)
    v_mfma_f32_16x16x32_bf16 v[8:11], v[64:67], v[180:183], v[8:11]
    ds_read_b128 v[92:95], v0 offset:5120
    v_mfma_f32_16x16x32_bf16 v[36:39], v[64:67], v[184:187], v[36:39]
    ds_read_b128 v[96:99], v0 offset:25600
    v_mfma_f32_16x16x32_bf16 v[12:15], v[68:71], v[180:183], v[12:15]
    ds_read_b128 v[100:103], v0 offset:46080
    v_mfma_f32_16x16x32_bf16 v[40:43], v[68:71], v[184:187], v[40:43]
    ds_read_b128 v[104:107], v229 offset:5120
    v_mfma_f32_16x16x32_bf16 v[16:19], v[72:75], v[180:183], v[16:19]
    ds_read_b128 v[108:111], v229 offset:25600
    v_mfma_f32_16x16x32_bf16 v[44:47], v[72:75], v[184:187], v[44:47]
    ds_read_b128 v[112:115], v229 offset:46080
    v_mfma_f32_16x16x32_bf16 v[20:23], v[76:79], v[180:183], v[20:23]
    ds_read_b128 v[116:119], v230 offset:5120
    v_mfma_f32_16x16x32_bf16 v[48:51], v[76:79], v[184:187], v[48:51]
    v_mfma_f32_16x16x32_bf16 v[24:27], v[80:83], v[180:183], v[24:27]
    buffer_load_dwordx4 a[72:75], v0, s[56:59], s69 offen offset:2048
    v_mfma_f32_16x16x32_bf16 v[52:55], v[80:83], v[184:187], v[52:55]
    v_mfma_f32_16x16x32_bf16 v[28:31], v[84:87], v[180:183], v[28:31]
    v_mfma_f32_16x16x32_bf16 v[56:59], v[84:87], v[184:187], v[56:59]
    buffer_load_dwordx4 a[76:79], v0, s[56:59], s69 offen offset:3072
    s_add_u32 s69, s69, 4096
    v_mfma_f32_16x16x32_bf16 v[32:35], v[88:91], v[180:183], v[32:35]
    v_mfma_f32_16x16x32_bf16 v[60:63], v[88:91], v[184:187], v[60:63]
    buffer_load_dwordx4 v[180:183], v0, s[32:35], s26 offen offset:2048
    buffer_load_dwordx4 v[184:187], v6, s[32:35], s26 offen offset:2048
    s_waitcnt vmcnt(22) lgkmcnt(0)
    v_mfma_f32_16x16x32_bf16 v[8:11], v[92:95], v[188:191], v[8:11]
    ds_read_b128 v[64:67], v0 offset:6144
    v_mfma_f32_16x16x32_bf16 v[36:39], v[92:95], v[192:195], v[36:39]
    ds_read_b128 v[68:71], v0 offset:26624
    v_mfma_f32_16x16x32_bf16 v[12:15], v[96:99], v[188:191], v[12:15]
    ds_read_b128 v[72:75], v0 offset:47104
    v_mfma_f32_16x16x32_bf16 v[40:43], v[96:99], v[192:195], v[40:43]
    ds_read_b128 v[76:79], v229 offset:6144
    v_mfma_f32_16x16x32_bf16 v[16:19], v[100:103], v[188:191], v[16:19]
    ds_read_b128 v[80:83], v229 offset:26624
    v_mfma_f32_16x16x32_bf16 v[44:47], v[100:103], v[192:195], v[44:47]
    ds_read_b128 v[84:87], v229 offset:47104
    v_mfma_f32_16x16x32_bf16 v[20:23], v[104:107], v[188:191], v[20:23]
    ds_read_b128 v[88:91], v230 offset:6144
    v_mfma_f32_16x16x32_bf16 v[48:51], v[104:107], v[192:195], v[48:51]
    v_mfma_f32_16x16x32_bf16 v[24:27], v[108:111], v[188:191], v[24:27]
    buffer_load_dwordx4 a[80:83], v0, s[56:59], s69 offen offset:0
    v_mfma_f32_16x16x32_bf16 v[52:55], v[108:111], v[192:195], v[52:55]
    v_mfma_f32_16x16x32_bf16 v[28:31], v[112:115], v[188:191], v[28:31]
    v_mfma_f32_16x16x32_bf16 v[56:59], v[112:115], v[192:195], v[56:59]
    buffer_load_dwordx4 a[84:87], v0, s[56:59], s69 offen offset:1024
    v_mfma_f32_16x16x32_bf16 v[32:35], v[116:119], v[188:191], v[32:35]
    v_mfma_f32_16x16x32_bf16 v[60:63], v[116:119], v[192:195], v[60:63]
    buffer_load_dwordx4 v[188:191], v0, s[32:35], s26 offen offset:3072
    buffer_load_dwordx4 v[192:195], v6, s[32:35], s26 offen offset:3072
    s_add_u32 s26, s26, 4096
    s_waitcnt vmcnt(21) lgkmcnt(0)
    v_mfma_f32_16x16x32_bf16 v[8:11], v[64:67], v[148:151], v[8:11]
    ds_read_b128 v[92:95], v0 offset:7168
    v_mfma_f32_16x16x32_bf16 v[36:39], v[64:67], v[152:155], v[36:39]
    ds_read_b128 v[96:99], v0 offset:27648
    v_mfma_f32_16x16x32_bf16 v[12:15], v[68:71], v[148:151], v[12:15]
    ds_read_b128 v[100:103], v0 offset:48128
    v_mfma_f32_16x16x32_bf16 v[40:43], v[68:71], v[152:155], v[40:43]
    ds_read_b128 v[104:107], v229 offset:7168
    v_mfma_f32_16x16x32_bf16 v[16:19], v[72:75], v[148:151], v[16:19]
    ds_read_b128 v[108:111], v229 offset:27648
    v_mfma_f32_16x16x32_bf16 v[44:47], v[72:75], v[152:155], v[44:47]
    ds_read_b128 v[112:115], v229 offset:48128
    v_mfma_f32_16x16x32_bf16 v[20:23], v[76:79], v[148:151], v[20:23]
    ds_read_b128 v[116:119], v230 offset:7168
    v_mfma_f32_16x16x32_bf16 v[48:51], v[76:79], v[152:155], v[48:51]
    v_mfma_f32_16x16x32_bf16 v[24:27], v[80:83], v[148:151], v[24:27]
    buffer_load_dwordx4 a[88:91], v0, s[56:59], s69 offen offset:2048
    v_mfma_f32_16x16x32_bf16 v[52:55], v[80:83], v[152:155], v[52:55]
    v_mfma_f32_16x16x32_bf16 v[28:31], v[84:87], v[148:151], v[28:31]
    v_mfma_f32_16x16x32_bf16 v[56:59], v[84:87], v[152:155], v[56:59]
    buffer_load_dwordx4 a[92:95], v0, s[56:59], s69 offen offset:3072
    s_add_u32 s69, s69, 4096
    v_mfma_f32_16x16x32_bf16 v[32:35], v[88:91], v[148:151], v[32:35]
    v_mfma_f32_16x16x32_bf16 v[60:63], v[88:91], v[152:155], v[60:63]
    buffer_load_dwordx4 v[148:151], v0, s[32:35], s26 offen offset:0
    buffer_load_dwordx4 v[152:155], v6, s[32:35], s26 offen offset:0
    s_waitcnt vmcnt(20) lgkmcnt(0)
    v_mfma_f32_16x16x32_bf16 v[8:11], v[92:95], v[156:159], v[8:11]
    ds_read_b128 v[64:67], v0 offset:8192
    v_mfma_f32_16x16x32_bf16 v[36:39], v[92:95], v[160:163], v[36:39]
    ds_read_b128 v[68:71], v0 offset:28672
    v_mfma_f32_16x16x32_bf16 v[12:15], v[96:99], v[156:159], v[12:15]
    ds_read_b128 v[72:75], v0 offset:49152
    v_mfma_f32_16x16x32_bf16 v[40:43], v[96:99], v[160:163], v[40:43]
    ds_read_b128 v[76:79], v229 offset:8192
    v_mfma_f32_16x16x32_bf16 v[16:19], v[100:103], v[156:159], v[16:19]
    ds_read_b128 v[80:83], v229 offset:28672
    v_mfma_f32_16x16x32_bf16 v[44:47], v[100:103], v[160:163], v[44:47]
    ds_read_b128 v[84:87], v229 offset:49152
    v_mfma_f32_16x16x32_bf16 v[20:23], v[104:107], v[156:159], v[20:23]
    ds_read_b128 v[88:91], v230 offset:8192
    v_mfma_f32_16x16x32_bf16 v[48:51], v[104:107], v[160:163], v[48:51]
    v_mfma_f32_16x16x32_bf16 v[24:27], v[108:111], v[156:159], v[24:27]
    buffer_load_dwordx4 a[96:99], v0, s[56:59], s69 offen offset:0
    v_mfma_f32_16x16x32_bf16 v[52:55], v[108:111], v[160:163], v[52:55]
    v_mfma_f32_16x16x32_bf16 v[28:31], v[112:115], v[156:159], v[28:31]
    v_mfma_f32_16x16x32_bf16 v[56:59], v[112:115], v[160:163], v[56:59]
    buffer_load_dwordx4 a[100:103], v0, s[56:59], s69 offen offset:1024
    v_mfma_f32_16x16x32_bf16 v[32:35], v[116:119], v[156:159], v[32:35]
    v_mfma_f32_16x16x32_bf16 v[60:63], v[116:119], v[160:163], v[60:63]
    buffer_load_dwordx4 v[156:159], v0, s[32:35], s26 offen offset:1024
    buffer_load_dwordx4 v[160:163], v6, s[32:35], s26 offen offset:1024
    s_waitcnt vmcnt(20) lgkmcnt(0)
    v_mfma_f32_16x16x32_bf16 v[8:11], v[64:67], v[164:167], v[8:11]
    ds_read_b128 v[92:95], v0 offset:9216
    v_mfma_f32_16x16x32_bf16 v[36:39], v[64:67], v[168:171], v[36:39]
    ds_read_b128 v[96:99], v0 offset:29696
    v_mfma_f32_16x16x32_bf16 v[12:15], v[68:71], v[164:167], v[12:15]
    ds_read_b128 v[100:103], v0 offset:50176
    v_mfma_f32_16x16x32_bf16 v[40:43], v[68:71], v[168:171], v[40:43]
    ds_read_b128 v[104:107], v229 offset:9216
    v_mfma_f32_16x16x32_bf16 v[16:19], v[72:75], v[164:167], v[16:19]
    ds_read_b128 v[108:111], v229 offset:29696
    v_mfma_f32_16x16x32_bf16 v[44:47], v[72:75], v[168:171], v[44:47]
    ds_read_b128 v[112:115], v229 offset:50176
    v_mfma_f32_16x16x32_bf16 v[20:23], v[76:79], v[164:167], v[20:23]
    ds_read_b128 v[116:119], v230 offset:9216
    v_mfma_f32_16x16x32_bf16 v[48:51], v[76:79], v[168:171], v[48:51]
    v_mfma_f32_16x16x32_bf16 v[24:27], v[80:83], v[164:167], v[24:27]
    buffer_load_dwordx4 a[104:107], v0, s[56:59], s69 offen offset:2048
    v_mfma_f32_16x16x32_bf16 v[52:55], v[80:83], v[168:171], v[52:55]
    v_mfma_f32_16x16x32_bf16 v[28:31], v[84:87], v[164:167], v[28:31]
    v_mfma_f32_16x16x32_bf16 v[56:59], v[84:87], v[168:171], v[56:59]
    buffer_load_dwordx4 a[108:111], v0, s[56:59], s69 offen offset:3072
    s_add_u32 s69, s69, 4096
    v_mfma_f32_16x16x32_bf16 v[32:35], v[88:91], v[164:167], v[32:35]
    v_mfma_f32_16x16x32_bf16 v[60:63], v[88:91], v[168:171], v[60:63]
    buffer_load_dwordx4 v[164:167], v0, s[32:35], s26 offen offset:2048
    buffer_load_dwordx4 v[168:171], v6, s[32:35], s26 offen offset:2048
    s_waitcnt vmcnt(20) lgkmcnt(0)
    v_mfma_f32_16x16x32_bf16 v[8:11], v[92:95], v[172:175], v[8:11]
    ds_read_b128 v[64:67], v0 offset:10240
    v_mfma_f32_16x16x32_bf16 v[36:39], v[92:95], v[176:179], v[36:39]
    ds_read_b128 v[68:71], v0 offset:30720
    v_mfma_f32_16x16x32_bf16 v[12:15], v[96:99], v[172:175], v[12:15]
    ds_read_b128 v[72:75], v0 offset:51200
    v_mfma_f32_16x16x32_bf16 v[40:43], v[96:99], v[176:179], v[40:43]
    ds_read_b128 v[76:79], v229 offset:10240
    v_mfma_f32_16x16x32_bf16 v[16:19], v[100:103], v[172:175], v[16:19]
    ds_read_b128 v[80:83], v229 offset:30720
    v_mfma_f32_16x16x32_bf16 v[44:47], v[100:103], v[176:179], v[44:47]
    ds_read_b128 v[84:87], v229 offset:51200
    v_mfma_f32_16x16x32_bf16 v[20:23], v[104:107], v[172:175], v[20:23]
    ds_read_b128 v[88:91], v230 offset:10240
    v_mfma_f32_16x16x32_bf16 v[48:51], v[104:107], v[176:179], v[48:51]
    v_mfma_f32_16x16x32_bf16 v[24:27], v[108:111], v[172:175], v[24:27]
    buffer_load_dwordx4 a[112:115], v0, s[56:59], s69 offen offset:0
    v_mfma_f32_16x16x32_bf16 v[52:55], v[108:111], v[176:179], v[52:55]
    v_mfma_f32_16x16x32_bf16 v[28:31], v[112:115], v[172:175], v[28:31]
    v_mfma_f32_16x16x32_bf16 v[56:59], v[112:115], v[176:179], v[56:59]
    buffer_load_dwordx4 a[116:119], v0, s[56:59], s69 offen offset:1024
    v_mfma_f32_16x16x32_bf16 v[32:35], v[116:119], v[172:175], v[32:35]
    v_mfma_f32_16x16x32_bf16 v[60:63], v[116:119], v[176:179], v[60:63]
    buffer_load_dwordx4 v[172:175], v0, s[32:35], s26 offen offset:3072
    buffer_load_dwordx4 v[176:179], v6, s[32:35], s26 offen offset:3072
    s_add_u32 s26, s26, 4096
    s_waitcnt vmcnt(20) lgkmcnt(0)
    v_mfma_f32_16x16x32_bf16 v[8:11], v[64:67], v[180:183], v[8:11]
    ds_read_b128 v[92:95], v0 offset:11264
    v_mfma_f32_16x16x32_bf16 v[36:39], v[64:67], v[184:187], v[36:39]
    ds_read_b128 v[96:99], v0 offset:31744
    v_mfma_f32_16x16x32_bf16 v[12:15], v[68:71], v[180:183], v[12:15]
    ds_read_b128 v[100:103], v0 offset:52224
    v_mfma_f32_16x16x32_bf16 v[40:43], v[68:71], v[184:187], v[40:43]
    ds_read_b128 v[104:107], v229 offset:11264
    v_mfma_f32_16x16x32_bf16 v[16:19], v[72:75], v[180:183], v[16:19]
    ds_read_b128 v[108:111], v229 offset:31744
    v_mfma_f32_16x16x32_bf16 v[44:47], v[72:75], v[184:187], v[44:47]
    ds_read_b128 v[112:115], v229 offset:52224
    v_mfma_f32_16x16x32_bf16 v[20:23], v[76:79], v[180:183], v[20:23]
    ds_read_b128 v[116:119], v230 offset:11264
    v_mfma_f32_16x16x32_bf16 v[48:51], v[76:79], v[184:187], v[48:51]
    v_mfma_f32_16x16x32_bf16 v[24:27], v[80:83], v[180:183], v[24:27]
    buffer_load_dwordx4 a[120:123], v0, s[56:59], s69 offen offset:2048
    v_mfma_f32_16x16x32_bf16 v[52:55], v[80:83], v[184:187], v[52:55]
    v_mfma_f32_16x16x32_bf16 v[28:31], v[84:87], v[180:183], v[28:31]
    v_mfma_f32_16x16x32_bf16 v[56:59], v[84:87], v[184:187], v[56:59]
    buffer_load_dwordx4 a[124:127], v0, s[56:59], s69 offen offset:3072
    s_add_u32 s69, s69, 4096
    v_mfma_f32_16x16x32_bf16 v[32:35], v[88:91], v[180:183], v[32:35]
    v_mfma_f32_16x16x32_bf16 v[60:63], v[88:91], v[184:187], v[60:63]
    buffer_load_dwordx4 v[180:183], v0, s[32:35], s26 offen offset:0
    buffer_load_dwordx4 v[184:187], v6, s[32:35], s26 offen offset:0
    s_waitcnt vmcnt(20) lgkmcnt(0)
    v_mfma_f32_16x16x32_bf16 v[8:11], v[92:95], v[188:191], v[8:11]
    ds_read_b128 v[64:67], v0 offset:12288
    v_mfma_f32_16x16x32_bf16 v[36:39], v[92:95], v[192:195], v[36:39]
    ds_read_b128 v[68:71], v0 offset:32768
    v_mfma_f32_16x16x32_bf16 v[12:15], v[96:99], v[188:191], v[12:15]
    ds_read_b128 v[72:75], v0 offset:53248
    v_mfma_f32_16x16x32_bf16 v[40:43], v[96:99], v[192:195], v[40:43]
    ds_read_b128 v[76:79], v229 offset:12288
    v_mfma_f32_16x16x32_bf16 v[16:19], v[100:103], v[188:191], v[16:19]
    ds_read_b128 v[80:83], v229 offset:32768
    v_mfma_f32_16x16x32_bf16 v[44:47], v[100:103], v[192:195], v[44:47]
    ds_read_b128 v[84:87], v229 offset:53248
    v_mfma_f32_16x16x32_bf16 v[20:23], v[104:107], v[188:191], v[20:23]
    ds_read_b128 v[88:91], v230 offset:12288
    v_mfma_f32_16x16x32_bf16 v[48:51], v[104:107], v[192:195], v[48:51]
    v_mfma_f32_16x16x32_bf16 v[24:27], v[108:111], v[188:191], v[24:27]
    buffer_load_dwordx4 a[128:131], v0, s[56:59], s69 offen offset:0
    v_mfma_f32_16x16x32_bf16 v[52:55], v[108:111], v[192:195], v[52:55]
    v_mfma_f32_16x16x32_bf16 v[28:31], v[112:115], v[188:191], v[28:31]
    v_mfma_f32_16x16x32_bf16 v[56:59], v[112:115], v[192:195], v[56:59]
    buffer_load_dwordx4 a[132:135], v0, s[56:59], s69 offen offset:1024
    v_mfma_f32_16x16x32_bf16 v[32:35], v[116:119], v[188:191], v[32:35]
    v_mfma_f32_16x16x32_bf16 v[60:63], v[116:119], v[192:195], v[60:63]
    buffer_load_dwordx4 v[188:191], v0, s[32:35], s26 offen offset:1024
    buffer_load_dwordx4 v[192:195], v6, s[32:35], s26 offen offset:1024
    s_waitcnt vmcnt(20) lgkmcnt(0)
    v_mfma_f32_16x16x32_bf16 v[8:11], v[64:67], v[148:151], v[8:11]
    ds_read_b128 v[92:95], v0 offset:13312
    v_mfma_f32_16x16x32_bf16 v[36:39], v[64:67], v[152:155], v[36:39]
    ds_read_b128 v[96:99], v0 offset:33792
    v_mfma_f32_16x16x32_bf16 v[12:15], v[68:71], v[148:151], v[12:15]
    ds_read_b128 v[100:103], v0 offset:54272
    v_mfma_f32_16x16x32_bf16 v[40:43], v[68:71], v[152:155], v[40:43]
    ds_read_b128 v[104:107], v229 offset:13312
    v_mfma_f32_16x16x32_bf16 v[16:19], v[72:75], v[148:151], v[16:19]
    ds_read_b128 v[108:111], v229 offset:33792
    v_mfma_f32_16x16x32_bf16 v[44:47], v[72:75], v[152:155], v[44:47]
    ds_read_b128 v[112:115], v229 offset:54272
    v_mfma_f32_16x16x32_bf16 v[20:23], v[76:79], v[148:151], v[20:23]
    ds_read_b128 v[116:119], v230 offset:13312
    v_mfma_f32_16x16x32_bf16 v[48:51], v[76:79], v[152:155], v[48:51]
    v_mfma_f32_16x16x32_bf16 v[24:27], v[80:83], v[148:151], v[24:27]
    buffer_load_dwordx4 a[136:139], v0, s[56:59], s69 offen offset:2048
    v_mfma_f32_16x16x32_bf16 v[52:55], v[80:83], v[152:155], v[52:55]
    v_mfma_f32_16x16x32_bf16 v[28:31], v[84:87], v[148:151], v[28:31]
    v_mfma_f32_16x16x32_bf16 v[56:59], v[84:87], v[152:155], v[56:59]
    buffer_load_dwordx4 a[140:143], v0, s[56:59], s69 offen offset:3072
    s_add_u32 s69, s69, 4096
    v_mfma_f32_16x16x32_bf16 v[32:35], v[88:91], v[148:151], v[32:35]
    v_mfma_f32_16x16x32_bf16 v[60:63], v[88:91], v[152:155], v[60:63]
    buffer_load_dwordx4 v[148:151], v0, s[32:35], s26 offen offset:2048
    buffer_load_dwordx4 v[152:155], v6, s[32:35], s26 offen offset:2048
    s_waitcnt vmcnt(20) lgkmcnt(0)
    v_mfma_f32_16x16x32_bf16 v[8:11], v[92:95], v[156:159], v[8:11]
    ds_read_b128 v[64:67], v0 offset:14336
    v_mfma_f32_16x16x32_bf16 v[36:39], v[92:95], v[160:163], v[36:39]
    ds_read_b128 v[68:71], v0 offset:34816
    v_mfma_f32_16x16x32_bf16 v[12:15], v[96:99], v[156:159], v[12:15]
    ds_read_b128 v[72:75], v0 offset:55296
    v_mfma_f32_16x16x32_bf16 v[40:43], v[96:99], v[160:163], v[40:43]
    ds_read_b128 v[76:79], v229 offset:14336
    v_mfma_f32_16x16x32_bf16 v[16:19], v[100:103], v[156:159], v[16:19]
    ds_read_b128 v[80:83], v229 offset:34816
    v_mfma_f32_16x16x32_bf16 v[44:47], v[100:103], v[160:163], v[44:47]
    ds_read_b128 v[84:87], v229 offset:55296
    v_mfma_f32_16x16x32_bf16 v[20:23], v[104:107], v[156:159], v[20:23]
    ds_read_b128 v[88:91], v230 offset:14336
    v_mfma_f32_16x16x32_bf16 v[48:51], v[104:107], v[160:163], v[48:51]
    v_mfma_f32_16x16x32_bf16 v[24:27], v[108:111], v[156:159], v[24:27]
    buffer_load_dwordx4 a[144:147], v0, s[56:59], s69 offen offset:0
    v_mfma_f32_16x16x32_bf16 v[52:55], v[108:111], v[160:163], v[52:55]
    v_mfma_f32_16x16x32_bf16 v[28:31], v[112:115], v[156:159], v[28:31]
    v_mfma_f32_16x16x32_bf16 v[56:59], v[112:115], v[160:163], v[56:59]
    buffer_load_dwordx4 a[148:151], v0, s[56:59], s69 offen offset:1024
    v_mfma_f32_16x16x32_bf16 v[32:35], v[116:119], v[156:159], v[32:35]
    v_mfma_f32_16x16x32_bf16 v[60:63], v[116:119], v[160:163], v[60:63]
    buffer_load_dwordx4 v[156:159], v0, s[32:35], s26 offen offset:3072
    buffer_load_dwordx4 v[160:163], v6, s[32:35], s26 offen offset:3072
    s_add_u32 s26, s26, 4096
    s_waitcnt vmcnt(20) lgkmcnt(0)
    v_mfma_f32_16x16x32_bf16 v[8:11], v[64:67], v[164:167], v[8:11]
    ds_read_b128 v[92:95], v0 offset:15360
    v_mfma_f32_16x16x32_bf16 v[36:39], v[64:67], v[168:171], v[36:39]
    ds_read_b128 v[96:99], v0 offset:35840
    v_mfma_f32_16x16x32_bf16 v[12:15], v[68:71], v[164:167], v[12:15]
    ds_read_b128 v[100:103], v0 offset:56320
    v_mfma_f32_16x16x32_bf16 v[40:43], v[68:71], v[168:171], v[40:43]
    ds_read_b128 v[104:107], v229 offset:15360
    v_mfma_f32_16x16x32_bf16 v[16:19], v[72:75], v[164:167], v[16:19]
    ds_read_b128 v[108:111], v229 offset:35840
    v_mfma_f32_16x16x32_bf16 v[44:47], v[72:75], v[168:171], v[44:47]
    ds_read_b128 v[112:115], v229 offset:56320
    v_mfma_f32_16x16x32_bf16 v[20:23], v[76:79], v[164:167], v[20:23]
    ds_read_b128 v[116:119], v230 offset:15360
    v_mfma_f32_16x16x32_bf16 v[48:51], v[76:79], v[168:171], v[48:51]
    v_mfma_f32_16x16x32_bf16 v[24:27], v[80:83], v[164:167], v[24:27]
    buffer_load_dwordx4 a[152:155], v0, s[56:59], s69 offen offset:2048
    v_mfma_f32_16x16x32_bf16 v[52:55], v[80:83], v[168:171], v[52:55]
    v_mfma_f32_16x16x32_bf16 v[28:31], v[84:87], v[164:167], v[28:31]
    v_mfma_f32_16x16x32_bf16 v[56:59], v[84:87], v[168:171], v[56:59]
    buffer_load_dwordx4 a[156:159], v0, s[56:59], s69 offen offset:3072
    s_add_u32 s69, s69, 4096
    v_mfma_f32_16x16x32_bf16 v[32:35], v[88:91], v[164:167], v[32:35]
    v_mfma_f32_16x16x32_bf16 v[60:63], v[88:91], v[168:171], v[60:63]
    s_waitcnt vmcnt(18) lgkmcnt(0)
    s_barrier
    v_mfma_f32_16x16x32_bf16 v[8:11], v[92:95], v[172:175], v[8:11]
    ds_read_b128 v[64:67], v0 offset:16384
    v_mfma_f32_16x16x32_bf16 v[36:39], v[92:95], v[176:179], v[36:39]
    ds_read_b128 v[68:71], v0 offset:36864
    v_mfma_f32_16x16x32_bf16 v[12:15], v[96:99], v[172:175], v[12:15]
    ds_read_b128 v[72:75], v0 offset:57344
    v_mfma_f32_16x16x32_bf16 v[40:43], v[96:99], v[176:179], v[40:43]
    ds_read_b128 v[76:79], v229 offset:16384
    v_mfma_f32_16x16x32_bf16 v[16:19], v[100:103], v[172:175], v[16:19]
    ds_read_b128 v[80:83], v229 offset:36864
    v_mfma_f32_16x16x32_bf16 v[44:47], v[100:103], v[176:179], v[44:47]
    ds_read_b128 v[84:87], v229 offset:57344
    v_mfma_f32_16x16x32_bf16 v[20:23], v[104:107], v[172:175], v[20:23]
    ds_read_b128 v[88:91], v230 offset:16384
    v_mfma_f32_16x16x32_bf16 v[48:51], v[104:107], v[176:179], v[48:51]
    v_mfma_f32_16x16x32_bf16 v[24:27], v[108:111], v[172:175], v[24:27]
    buffer_load_dwordx4 a[160:163], v0, s[56:59], s69 offen offset:0
    v_mfma_f32_16x16x32_bf16 v[52:55], v[108:111], v[176:179], v[52:55]
    v_mfma_f32_16x16x32_bf16 v[28:31], v[112:115], v[172:175], v[28:31]
    v_mfma_f32_16x16x32_bf16 v[56:59], v[112:115], v[176:179], v[56:59]
    buffer_load_dwordx4 a[164:167], v0, s[56:59], s69 offen offset:1024
    v_mfma_f32_16x16x32_bf16 v[32:35], v[116:119], v[172:175], v[32:35]
    v_mfma_f32_16x16x32_bf16 v[60:63], v[116:119], v[176:179], v[60:63]
    s_waitcnt vmcnt(16) lgkmcnt(0)
    v_mfma_f32_16x16x32_bf16 v[8:11], v[64:67], v[180:183], v[8:11]
    ds_read_b128 v[92:95], v0 offset:17408
    v_mfma_f32_16x16x32_bf16 v[36:39], v[64:67], v[184:187], v[36:39]
    ds_read_b128 v[96:99], v0 offset:37888
    v_mfma_f32_16x16x32_bf16 v[12:15], v[68:71], v[180:183], v[12:15]
    ds_read_b128 v[100:103], v0 offset:58368
    v_mfma_f32_16x16x32_bf16 v[40:43], v[68:71], v[184:187], v[40:43]
    ds_read_b128 v[104:107], v229 offset:17408
    v_mfma_f32_16x16x32_bf16 v[16:19], v[72:75], v[180:183], v[16:19]
    ds_read_b128 v[108:111], v229 offset:37888
    v_mfma_f32_16x16x32_bf16 v[44:47], v[72:75], v[184:187], v[44:47]
    ds_read_b128 v[112:115], v229 offset:58368
    v_mfma_f32_16x16x32_bf16 v[20:23], v[76:79], v[180:183], v[20:23]
    ds_read_b128 v[116:119], v230 offset:17408
    v_mfma_f32_16x16x32_bf16 v[48:51], v[76:79], v[184:187], v[48:51]
    v_mfma_f32_16x16x32_bf16 v[24:27], v[80:83], v[180:183], v[24:27]
    buffer_load_dwordx4 a[168:171], v0, s[56:59], s69 offen offset:2048
    v_mfma_f32_16x16x32_bf16 v[52:55], v[80:83], v[184:187], v[52:55]
    v_mfma_f32_16x16x32_bf16 v[28:31], v[84:87], v[180:183], v[28:31]
    v_mfma_f32_16x16x32_bf16 v[56:59], v[84:87], v[184:187], v[56:59]
    buffer_load_dwordx4 a[172:175], v0, s[56:59], s69 offen offset:3072
    s_add_u32 s69, s69, 4096
    v_mfma_f32_16x16x32_bf16 v[32:35], v[88:91], v[180:183], v[32:35]
    v_mfma_f32_16x16x32_bf16 v[60:63], v[88:91], v[184:187], v[60:63]
    s_waitcnt vmcnt(14) lgkmcnt(0)
    v_mfma_f32_16x16x32_bf16 v[8:11], v[92:95], v[188:191], v[8:11]
    ds_read_b128 v[64:67], v0 offset:18432
    v_mfma_f32_16x16x32_bf16 v[36:39], v[92:95], v[192:195], v[36:39]
    ds_read_b128 v[68:71], v0 offset:38912
    v_mfma_f32_16x16x32_bf16 v[12:15], v[96:99], v[188:191], v[12:15]
    ds_read_b128 v[72:75], v0 offset:59392
    v_mfma_f32_16x16x32_bf16 v[40:43], v[96:99], v[192:195], v[40:43]
    ds_read_b128 v[76:79], v229 offset:18432
    v_mfma_f32_16x16x32_bf16 v[16:19], v[100:103], v[188:191], v[16:19]
    ds_read_b128 v[80:83], v229 offset:38912
    v_mfma_f32_16x16x32_bf16 v[44:47], v[100:103], v[192:195], v[44:47]
    ds_read_b128 v[84:87], v229 offset:59392
    v_mfma_f32_16x16x32_bf16 v[20:23], v[104:107], v[188:191], v[20:23]
    ds_read_b128 v[88:91], v230 offset:18432
    v_mfma_f32_16x16x32_bf16 v[48:51], v[104:107], v[192:195], v[48:51]
    v_mfma_f32_16x16x32_bf16 v[24:27], v[108:111], v[188:191], v[24:27]
    buffer_load_dwordx4 a[176:179], v0, s[56:59], s69 offen offset:0
    v_mfma_f32_16x16x32_bf16 v[52:55], v[108:111], v[192:195], v[52:55]
    v_mfma_f32_16x16x32_bf16 v[28:31], v[112:115], v[188:191], v[28:31]
    v_mfma_f32_16x16x32_bf16 v[56:59], v[112:115], v[192:195], v[56:59]
    buffer_load_dwordx4 a[180:183], v0, s[56:59], s69 offen offset:1024
    v_mfma_f32_16x16x32_bf16 v[32:35], v[116:119], v[188:191], v[32:35]
    v_mfma_f32_16x16x32_bf16 v[60:63], v[116:119], v[192:195], v[60:63]
    s_waitcnt vmcnt(12) lgkmcnt(0)
    v_mfma_f32_16x16x32_bf16 v[8:11], v[64:67], v[148:151], v[8:11]
    ds_read_b128 v[92:95], v0 offset:19456
    ds_read_b128 v[96:99], v0 offset:39936
    v_mfma_f32_16x16x32_bf16 v[36:39], v[64:67], v[152:155], v[36:39]
    ds_read_b128 v[100:103], v0 offset:60416
    ds_read_b128 v[104:107], v229 offset:19456
    v_mfma_f32_16x16x32_bf16 v[12:15], v[68:71], v[148:151], v[12:15]
    ds_read_b128 v[108:111], v229 offset:39936
    ds_read_b128 v[112:115], v229 offset:60416
    v_mfma_f32_16x16x32_bf16 v[40:43], v[68:71], v[152:155], v[40:43]
    ds_read_b128 v[116:119], v230 offset:19456
    v_mfma_f32_16x16x32_bf16 v[16:19], v[72:75], v[148:151], v[16:19]
    v_mfma_f32_16x16x32_bf16 v[44:47], v[72:75], v[152:155], v[44:47]
    v_mfma_f32_16x16x32_bf16 v[20:23], v[76:79], v[148:151], v[20:23]
    v_mfma_f32_16x16x32_bf16 v[48:51], v[76:79], v[152:155], v[48:51]
    s_waitcnt vmcnt(8) lgkmcnt(0)
    v_mfma_f32_16x16x32_bf16 v[8:11], v[92:95], v[156:159], v[8:11]
    v_mfma_f32_16x16x32_bf16 v[36:39], v[92:95], v[160:163], v[36:39]
    v_mfma_f32_16x16x32_bf16 v[12:15], v[96:99], v[156:159], v[12:15]
    v_mfma_f32_16x16x32_bf16 v[40:43], v[96:99], v[160:163], v[40:43]
    v_mfma_f32_16x16x32_bf16 v[24:27], v[80:83], v[148:151], v[24:27]
    s_nop 3
    v_max_f32 v164, 0, v8
    v_max_f32 v165, 0, v9
    v_max_f32 v166, 0, v10
    v_mfma_f32_16x16x32_bf16 v[52:55], v[80:83], v[152:155], v[52:55]
    v_max_f32 v167, 0, v11
    v_pk_mul_f32 v[164:165], v[164:165], v[164:165]
    v_pk_mul_f32 v[166:167], v[166:167], v[166:167]
    v_mfma_f32_16x16x32_bf16 v[28:31], v[84:87], v[148:151], v[28:31]
    v_cvt_pk_bf16_f32 v172, v164, v165
    v_cvt_pk_bf16_f32 v173, v166, v167
    v_max_f32 v168, 0, v12
    v_mfma_f32_16x16x32_bf16 v[56:59], v[84:87], v[152:155], v[56:59]
    v_max_f32 v169, 0, v13
    v_max_f32 v170, 0, v14
    v_max_f32 v171, 0, v15
    v_mfma_f32_16x16x32_bf16 v[16:19], v[100:103], v[156:159], v[16:19]
    v_pk_mul_f32 v[168:169], v[168:169], v[168:169]
    v_pk_mul_f32 v[170:171], v[170:171], v[170:171]
    v_cvt_pk_bf16_f32 v174, v168, v169
    v_mfma_f32_16x16x32_bf16 v[44:47], v[100:103], v[160:163], v[44:47]
    v_cvt_pk_bf16_f32 v175, v170, v171
    buffer_store_dwordx4 v[172:175], v0, s[36:39], s40 offen offset:0 sc1
    v_max_f32 v176, 0, v36
    v_mfma_f32_16x16x32_bf16 v[20:23], v[104:107], v[156:159], v[20:23]
    v_max_f32 v177, 0, v37
    v_max_f32 v178, 0, v38
    v_max_f32 v179, 0, v39
    v_mfma_f32_16x16x32_bf16 v[48:51], v[104:107], v[160:163], v[48:51]
    v_pk_mul_f32 v[176:177], v[176:177], v[176:177]
    v_pk_mul_f32 v[178:179], v[178:179], v[178:179]
    v_cvt_pk_bf16_f32 v184, v176, v177
    v_mfma_f32_16x16x32_bf16 v[32:35], v[88:91], v[148:151], v[32:35]
    v_cvt_pk_bf16_f32 v185, v178, v179
    v_max_f32 v180, 0, v40
    v_max_f32 v181, 0, v41
    v_mfma_f32_16x16x32_bf16 v[60:63], v[88:91], v[152:155], v[60:63]
    v_max_f32 v182, 0, v42
    v_max_f32 v183, 0, v43
    v_pk_mul_f32 v[180:181], v[180:181], v[180:181]
    v_mfma_f32_16x16x32_bf16 v[24:27], v[108:111], v[156:159], v[24:27]
    v_pk_mul_f32 v[182:183], v[182:183], v[182:183]
    v_cvt_pk_bf16_f32 v186, v180, v181
    v_cvt_pk_bf16_f32 v187, v182, v183
    v_mfma_f32_16x16x32_bf16 v[52:55], v[108:111], v[160:163], v[52:55]
    buffer_store_dwordx4 v[184:187], v4, s[36:39], s40 offen offset:0 sc1
    v_max_f32 v164, 0, v16
    v_max_f32 v165, 0, v17
    v_mfma_f32_16x16x32_bf16 v[28:31], v[112:115], v[156:159], v[28:31]
    v_max_f32 v166, 0, v18
    v_max_f32 v167, 0, v19
    v_pk_mul_f32 v[164:165], v[164:165], v[164:165]
    v_mfma_f32_16x16x32_bf16 v[56:59], v[112:115], v[160:163], v[56:59]
    v_pk_mul_f32 v[166:167], v[166:167], v[166:167]
    v_cvt_pk_bf16_f32 v172, v164, v165
    v_cvt_pk_bf16_f32 v173, v166, v167
    v_mfma_f32_16x16x32_bf16 v[32:35], v[116:119], v[156:159], v[32:35]
    v_max_f32 v168, 0, v20
    v_max_f32 v169, 0, v21
    v_max_f32 v170, 0, v22
    v_mfma_f32_16x16x32_bf16 v[60:63], v[116:119], v[160:163], v[60:63]
    v_max_f32 v171, 0, v23
    v_pk_mul_f32 v[168:169], v[168:169], v[168:169]
    v_pk_mul_f32 v[170:171], v[170:171], v[170:171]
    v_cvt_pk_bf16_f32 v174, v168, v169
    v_cvt_pk_bf16_f32 v175, v170, v171
    buffer_store_dwordx4 v[172:175], v0, s[36:39], s40 offen offset:1024 sc1
    v_max_f32 v176, 0, v44
    v_max_f32 v177, 0, v45
    v_max_f32 v178, 0, v46
    v_max_f32 v179, 0, v47
    v_pk_mul_f32 v[176:177], v[176:177], v[176:177]
    v_pk_mul_f32 v[178:179], v[178:179], v[178:179]
    v_cvt_pk_bf16_f32 v184, v176, v177
    v_cvt_pk_bf16_f32 v185, v178, v179
    v_max_f32 v180, 0, v48
    v_max_f32 v181, 0, v49
    v_max_f32 v182, 0, v50
    v_max_f32 v183, 0, v51
    v_pk_mul_f32 v[180:181], v[180:181], v[180:181]
    v_pk_mul_f32 v[182:183], v[182:183], v[182:183]
    v_cvt_pk_bf16_f32 v186, v180, v181
    v_cvt_pk_bf16_f32 v187, v182, v183
    buffer_store_dwordx4 v[184:187], v4, s[36:39], s40 offen offset:1024 sc1
    v_max_f32 v164, 0, v24
    v_max_f32 v165, 0, v25
    v_max_f32 v166, 0, v26
    v_max_f32 v167, 0, v27
    v_pk_mul_f32 v[164:165], v[164:165], v[164:165]
    v_pk_mul_f32 v[166:167], v[166:167], v[166:167]
    v_cvt_pk_bf16_f32 v172, v164, v165
    v_cvt_pk_bf16_f32 v173, v166, v167
    v_max_f32 v168, 0, v28
    v_max_f32 v169, 0, v29
    v_max_f32 v170, 0, v30
    v_max_f32 v171, 0, v31
    v_pk_mul_f32 v[168:169], v[168:169], v[168:169]
    v_pk_mul_f32 v[170:171], v[170:171], v[170:171]
    v_cvt_pk_bf16_f32 v174, v168, v169
    v_cvt_pk_bf16_f32 v175, v170, v171
    buffer_store_dwordx4 v[172:175], v0, s[36:39], s40 offen offset:2048 sc1
    v_max_f32 v176, 0, v52
    v_max_f32 v177, 0, v53
    v_max_f32 v178, 0, v54
    v_max_f32 v179, 0, v55
    v_pk_mul_f32 v[176:177], v[176:177], v[176:177]
    v_pk_mul_f32 v[178:179], v[178:179], v[178:179]
    v_cvt_pk_bf16_f32 v184, v176, v177
    v_cvt_pk_bf16_f32 v185, v178, v179
    v_max_f32 v180, 0, v56
    v_max_f32 v181, 0, v57
    v_max_f32 v182, 0, v58
    v_max_f32 v183, 0, v59
    v_pk_mul_f32 v[180:181], v[180:181], v[180:181]
    v_pk_mul_f32 v[182:183], v[182:183], v[182:183]
    v_cvt_pk_bf16_f32 v186, v180, v181
    v_cvt_pk_bf16_f32 v187, v182, v183
    buffer_store_dwordx4 v[184:187], v4, s[36:39], s40 offen offset:2048 sc1
    v_max_f32 v164, 0, v32
    v_max_f32 v165, 0, v33
    v_max_f32 v166, 0, v34
    v_max_f32 v167, 0, v35
    v_pk_mul_f32 v[164:165], v[164:165], v[164:165]
    v_pk_mul_f32 v[166:167], v[166:167], v[166:167]
    v_cvt_pk_bf16_f32 v188, v164, v165
    v_cvt_pk_bf16_f32 v189, v166, v167
    v_max_f32 v176, 0, v60
    v_max_f32 v177, 0, v61
    v_max_f32 v178, 0, v62
    v_max_f32 v179, 0, v63
    v_pk_mul_f32 v[176:177], v[176:177], v[176:177]
    v_pk_mul_f32 v[178:179], v[178:179], v[178:179]
    v_cvt_pk_bf16_f32 v190, v176, v177
    v_cvt_pk_bf16_f32 v191, v178, v179
    s_nop 0
    v_permlane16_swap_b32 v188, v190
    v_permlane16_swap_b32 v189, v191
    buffer_store_dwordx4 v[188:191], v5, s[36:39], s41 offen sc1
    s_lshl_b32 s21, s3, 6
    s_lshl_b32 s22, s20, 2
    s_add_u32 s21, s21, s22
    s_add_u32 s21, s21, 24576
    s_waitcnt vmcnt(0)
    s_mov_b64 exec, 1
    buffer_store_dword v6, v0, s[64:67], s21 offen sc0 sc1
    s_mov_b64 exec, -1
    s_lshr_b32 s23, s98, 3
    s_and_b32 s24, s98, 7
    s_mul_i32 s24, s24, 160
    s_lshl_b32 s48, s23, 2
    s_add_u32 s48, s48, s20
    s_mul_i32 s48, s48, 20480
    s_add_u32 s48, s48, s24
    s_add_u32 s28, s18, 15335424
    s_addc_u32 s29, s19, 0
    s_mov_b32 s30, 2621440
    s_mov_b32 s31, 0x20000
    v_mov_b32 v92, v196
    v_mov_b32 v2, v199
    v_mov_b32 v93, v197
    v_mov_b32 v3, v200
    v_mov_b32 v94, v198
    v_mov_b32 v4, v201
    buffer_load_dwordx4 a[184:187], v0, s[56:59], s69 offen offset:2048
    buffer_load_dwordx4 a[188:191], v0, s[56:59], s69 offen offset:3072
    s_add_u32 s69, s69, 4096
    buffer_load_dwordx4 a[192:195], v0, s[56:59], s69 offen offset:0
    buffer_load_dwordx4 a[196:199], v0, s[56:59], s69 offen offset:1024
    buffer_load_dwordx4 a[200:203], v0, s[56:59], s69 offen offset:2048
    buffer_load_dwordx4 a[204:207], v0, s[56:59], s69 offen offset:3072
    s_add_u32 s69, s69, 4096
    buffer_load_dwordx4 a[208:211], v0, s[56:59], s69 offen offset:0
    buffer_load_dwordx4 a[212:215], v0, s[56:59], s69 offen offset:1024
    buffer_load_dwordx4 a[216:219], v0, s[56:59], s69 offen offset:2048
    buffer_load_dwordx4 a[220:223], v0, s[56:59], s69 offen offset:3072
    s_add_u32 s69, s69, 4096
    buffer_load_dwordx4 a[224:227], v0, s[56:59], s69 offen offset:0
    buffer_load_dwordx4 a[228:231], v0, s[56:59], s69 offen offset:1024
    buffer_load_dwordx4 a[232:235], v0, s[56:59], s69 offen offset:2048
    buffer_load_dwordx4 a[236:239], v0, s[56:59], s69 offen offset:3072
    s_add_u32 s69, s69, 4096
    buffer_load_dwordx4 a[240:243], v0, s[56:59], s69 offen offset:0
    buffer_load_dwordx4 a[244:247], v0, s[56:59], s69 offen offset:1024
    buffer_load_dwordx4 a[248:251], v0, s[56:59], s69 offen offset:2048
    buffer_load_dwordx4 a[252:255], v0, s[56:59], s69 offen offset:3072
    s_add_u32 s69, s69, 4096
    buffer_load_dwordx4 v[232:235], v0, s[56:59], s69 offen offset:0
    buffer_load_dwordx4 v[236:239], v0, s[56:59], s69 offen offset:1024
    buffer_load_dwordx4 v[240:243], v0, s[56:59], s69 offen offset:2048
    buffer_load_dwordx4 v[244:247], v0, s[56:59], s69 offen offset:3072
    s_add_u32 s69, s69, 4096
    buffer_load_dwordx4 v[248:251], v0, s[56:59], s69 offen offset:0
    buffer_load_dwordx4 v[252:255], v0, s[56:59], s69 offen offset:1024
    s_mul_i32 s26, s23, 229376
    s_lshl_b32 s25, s20, 10
    s_add_u32 s26, s26, s25
    s_add_u32 s50, s20, 0
    s_and_b32 s50, s50, 3
    s_mul_i32 s51, s50, 57344
    v_add_u32 v88, s51, v0
    s_mul_i32 s40, s50, 21120
    s_add_u32 s50, s20, 1
    s_and_b32 s50, s50, 3
    s_mul_i32 s51, s50, 57344
    v_add_u32 v89, s51, v0
    s_mul_i32 s41, s50, 21120
    s_add_u32 s50, s20, 2
    s_and_b32 s50, s50, 3
    s_mul_i32 s51, s50, 57344
    v_add_u32 v90, s51, v0
    s_mul_i32 s42, s50, 21120
    s_add_u32 s50, s20, 3
    s_and_b32 s50, s50, 3
    s_mul_i32 s51, s50, 57344
    v_add_u32 v91, s51, v0
    s_mul_i32 s43, s50, 21120
    v_lshrrev_b32 v5, 5, v1
    v_lshl_add_u32 v95, v5, 4, v0
    s_mov_b32 s44, s62
    s_mov_b32 s45, s63
    s_mov_b32 s46, 2621440
    s_mov_b32 s47, 0x20000
    s_and_b32 s21, s98, 0xf0
    s_lshl_b32 s21, s21, 6
    s_and_b32 s25, s98, 8
    s_add_u32 s21, s21, s25
    s_add_u32 s21, s21, 24576
    s_cmp_lg_u32 s20, 1
    s_cbranch_scc1 KF_pd3
    v_lshlrev_b32 v100, 6, v1
    s_mov_b64 exec, 0xffff
    s_mov_b32 s72, 32768
KF_pl3:
    buffer_load_dwordx2 v[96:97], v100, s[64:67], s21 offen sc0 sc1
    s_waitcnt vmcnt(0)
    v_min_u32 v96, v96, v97
    v_cmp_eq_u32 vcc, 0, v96
    s_sub_u32 s72, s72, 1
    s_nop 2
    s_cbranch_scc1 KF_pe3
    s_cbranch_vccz KF_pe3
    s_mov_b64 exec, vcc
    s_branch KF_pl3
KF_pe3:
    s_mov_b64 exec, -1
KF_pd3:
    s_barrier
    buffer_load_dwordx4 v[100:103], v89, s[36:39], s26 offen
    buffer_load_dwordx4 v[104:107], v90, s[36:39], s26 offen
    buffer_load_dwordx4 v[108:111], v91, s[36:39], s26 offen
    buffer_load_dwordx4 v[96:99], v88, s[36:39], s26 offen
    s_add_u32 s26, s26, 4096
    buffer_load_dwordx4 v[116:119], v89, s[36:39], s26 offen
    buffer_load_dwordx4 v[120:123], v90, s[36:39], s26 offen
    buffer_load_dwordx4 v[124:127], v91, s[36:39], s26 offen
    buffer_load_dwordx4 v[112:115], v88, s[36:39], s26 offen
    s_add_u32 s26, s26, 4096
    buffer_load_dwordx4 v[132:135], v89, s[36:39], s26 offen
    buffer_load_dwordx4 v[136:139], v90, s[36:39], s26 offen
    buffer_load_dwordx4 v[140:143], v91, s[36:39], s26 offen
    buffer_load_dwordx4 v[128:131], v88, s[36:39], s26 offen
    s_add_u32 s26, s26, 4096
    s_waitcnt vmcnt(11)
    v_mfma_f32_16x16x32_bf16 v[28:31], a[0:3], v[100:103], 0
    v_mfma_f32_16x16x32_bf16 v[32:35], a[4:7], v[100:103], 0
    v_mfma_f32_16x16x32_bf16 v[36:39], a[8:11], v[100:103], 0
    v_mfma_f32_16x16x32_bf16 v[40:43], a[12:15], v[100:103], 0
    v_mfma_f32_16x16x32_bf16 v[44:47], a[16:19], v[100:103], 0
    buffer_load_dwordx4 v[148:151], v89, s[36:39], s26 offen
    buffer_load_dwordx4 v[152:155], v90, s[36:39], s26 offen
    s_waitcnt vmcnt(12)
    v_mfma_f32_16x16x32_bf16 v[48:51], a[0:3], v[104:107], 0
    v_mfma_f32_16x16x32_bf16 v[52:55], a[4:7], v[104:107], 0
    v_mfma_f32_16x16x32_bf16 v[56:59], a[8:11], v[104:107], 0
    v_mfma_f32_16x16x32_bf16 v[60:63], a[12:15], v[104:107], 0
    v_mfma_f32_16x16x32_bf16 v[64:67], a[16:19], v[104:107], 0
    buffer_load_dwordx4 v[156:159], v91, s[36:39], s26 offen
    buffer_load_dwordx4 v[144:147], v88, s[36:39], s26 offen
    s_add_u32 s26, s26, 4096
    s_waitcnt vmcnt(13)
    v_mfma_f32_16x16x32_bf16 v[68:71], a[0:3], v[108:111], 0
    v_mfma_f32_16x16x32_bf16 v[72:75], a[4:7], v[108:111], 0
    v_mfma_f32_16x16x32_bf16 v[76:79], a[8:11], v[108:111], 0
    v_mfma_f32_16x16x32_bf16 v[80:83], a[12:15], v[108:111], 0
    v_mfma_f32_16x16x32_bf16 v[84:87], a[16:19], v[108:111], 0
    buffer_load_dwordx4 v[164:167], v89, s[36:39], s26 offen
    buffer_load_dwordx4 v[168:171], v90, s[36:39], s26 offen
    s_waitcnt vmcnt(14)
    v_mfma_f32_16x16x32_bf16 v[8:11], a[0:3], v[96:99], 0
    v_mfma_f32_16x16x32_bf16 v[12:15], a[4:7], v[96:99], 0
    v_mfma_f32_16x16x32_bf16 v[16:19], a[8:11], v[96:99], 0
    v_mfma_f32_16x16x32_bf16 v[20:23], a[12:15], v[96:99], 0
    v_mfma_f32_16x16x32_bf16 v[24:27], a[16:19], v[96:99], 0
    buffer_load_dwordx4 v[172:175], v91, s[36:39], s26 offen
    buffer_load_dwordx4 v[160:163], v88, s[36:39], s26 offen
    s_add_u32 s26, s26, 4096
    s_waitcnt vmcnt(15)
    v_mfma_f32_16x16x32_bf16 v[28:31], a[20:23], v[116:119], v[28:31]
    v_mfma_f32_16x16x32_bf16 v[32:35], a[24:27], v[116:119], v[32:35]
    v_mfma_f32_16x16x32_bf16 v[36:39], a[28:31], v[116:119], v[36:39]
    v_mfma_f32_16x16x32_bf16 v[40:43], a[32:35], v[116:119], v[40:43]
    v_mfma_f32_16x16x32_bf16 v[44:47], a[36:39], v[116:119], v[44:47]
    buffer_load_dwordx4 v[180:183], v89, s[36:39], s26 offen
    buffer_load_dwordx4 v[184:187], v90, s[36:39], s26 offen
    s_waitcnt vmcnt(16)
    v_mfma_f32_16x16x32_bf16 v[48:51], a[20:23], v[120:123], v[48:51]
    v_mfma_f32_16x16x32_bf16 v[52:55], a[24:27], v[120:123], v[52:55]
    v_mfma_f32_16x16x32_bf16 v[56:59], a[28:31], v[120:123], v[56:59]
    v_mfma_f32_16x16x32_bf16 v[60:63], a[32:35], v[120:123], v[60:63]
    v_mfma_f32_16x16x32_bf16 v[64:67], a[36:39], v[120:123], v[64:67]
    buffer_load_dwordx4 v[188:191], v91, s[36:39], s26 offen
    buffer_load_dwordx4 v[176:179], v88, s[36:39], s26 offen
    s_add_u32 s26, s26, 4096
    s_waitcnt vmcnt(17)
    v_mfma_f32_16x16x32_bf16 v[68:71], a[20:23], v[124:127], v[68:71]
    v_mfma_f32_16x16x32_bf16 v[72:75], a[24:27], v[124:127], v[72:75]
    v_mfma_f32_16x16x32_bf16 v[76:79], a[28:31], v[124:127], v[76:79]
    v_mfma_f32_16x16x32_bf16 v[80:83], a[32:35], v[124:127], v[80:83]
    v_mfma_f32_16x16x32_bf16 v[84:87], a[36:39], v[124:127], v[84:87]
    buffer_load_dwordx4 v[196:199], v89, s[36:39], s26 offen
    buffer_load_dwordx4 v[200:203], v90, s[36:39], s26 offen
    s_waitcnt vmcnt(18)
    v_mfma_f32_16x16x32_bf16 v[8:11], a[20:23], v[112:115], v[8:11]
    v_mfma_f32_16x16x32_bf16 v[12:15], a[24:27], v[112:115], v[12:15]
    v_mfma_f32_16x16x32_bf16 v[16:19], a[28:31], v[112:115], v[16:19]
    v_mfma_f32_16x16x32_bf16 v[20:23], a[32:35], v[112:115], v[20:23]
    v_mfma_f32_16x16x32_bf16 v[24:27], a[36:39], v[112:115], v[24:27]
    buffer_load_dwordx4 v[204:207], v91, s[36:39], s26 offen
    buffer_load_dwordx4 v[192:195], v88, s[36:39], s26 offen
    s_add_u32 s26, s26, 4096
    s_waitcnt vmcnt(19)
    v_mfma_f32_16x16x32_bf16 v[28:31], a[40:43], v[132:135], v[28:31]
    v_mfma_f32_16x16x32_bf16 v[32:35], a[44:47], v[132:135], v[32:35]
    v_mfma_f32_16x16x32_bf16 v[36:39], a[48:51], v[132:135], v[36:39]
    v_mfma_f32_16x16x32_bf16 v[40:43], a[52:55], v[132:135], v[40:43]
    v_mfma_f32_16x16x32_bf16 v[44:47], a[56:59], v[132:135], v[44:47]
    buffer_load_dwordx4 v[100:103], v89, s[36:39], s26 offen
    buffer_load_dwordx4 v[104:107], v90, s[36:39], s26 offen
    s_waitcnt vmcnt(20)
    v_mfma_f32_16x16x32_bf16 v[48:51], a[40:43], v[136:139], v[48:51]
    v_mfma_f32_16x16x32_bf16 v[52:55], a[44:47], v[136:139], v[52:55]
    v_mfma_f32_16x16x32_bf16 v[56:59], a[48:51], v[136:139], v[56:59]
    v_mfma_f32_16x16x32_bf16 v[60:63], a[52:55], v[136:139], v[60:63]
    v_mfma_f32_16x16x32_bf16 v[64:67], a[56:59], v[136:139], v[64:67]
    buffer_load_dwordx4 v[108:111], v91, s[36:39], s26 offen
    buffer_load_dwordx4 v[96:99], v88, s[36:39], s26 offen
    s_add_u32 s26, s26, 4096
    s_waitcnt vmcnt(21)
    v_mfma_f32_16x16x32_bf16 v[68:71], a[40:43], v[140:143], v[68:71]
    v_mfma_f32_16x16x32_bf16 v[72:75], a[44:47], v[140:143], v[72:75]
    v_mfma_f32_16x16x32_bf16 v[76:79], a[48:51], v[140:143], v[76:79]
    v_mfma_f32_16x16x32_bf16 v[80:83], a[52:55], v[140:143], v[80:83]
    v_mfma_f32_16x16x32_bf16 v[84:87], a[56:59], v[140:143], v[84:87]
    buffer_load_dwordx4 v[116:119], v89, s[36:39], s26 offen
    buffer_load_dwordx4 v[120:123], v90, s[36:39], s26 offen
    s_waitcnt vmcnt(22)
    v_mfma_f32_16x16x32_bf16 v[8:11], a[40:43], v[128:131], v[8:11]
    v_mfma_f32_16x16x32_bf16 v[12:15], a[44:47], v[128:131], v[12:15]
    v_mfma_f32_16x16x32_bf16 v[16:19], a[48:51], v[128:131], v[16:19]
    v_mfma_f32_16x16x32_bf16 v[20:23], a[52:55], v[128:131], v[20:23]
    v_mfma_f32_16x16x32_bf16 v[24:27], a[56:59], v[128:131], v[24:27]
    buffer_load_dwordx4 v[124:127], v91, s[36:39], s26 offen
    buffer_load_dwordx4 v[112:115], v88, s[36:39], s26 offen
    s_add_u32 s26, s26, 4096
    s_waitcnt vmcnt(23)
    v_mfma_f32_16x16x32_bf16 v[28:31], a[60:63], v[148:151], v[28:31]
    v_mfma_f32_16x16x32_bf16 v[32:35], a[64:67], v[148:151], v[32:35]
    v_mfma_f32_16x16x32_bf16 v[36:39], a[68:71], v[148:151], v[36:39]
    v_mfma_f32_16x16x32_bf16 v[40:43], a[72:75], v[148:151], v[40:43]
    v_mfma_f32_16x16x32_bf16 v[44:47], a[76:79], v[148:151], v[44:47]
    buffer_load_dwordx4 v[132:135], v89, s[36:39], s26 offen
    buffer_load_dwordx4 v[136:139], v90, s[36:39], s26 offen
    s_waitcnt vmcnt(24)
    v_mfma_f32_16x16x32_bf16 v[48:51], a[60:63], v[152:155], v[48:51]
    v_mfma_f32_16x16x32_bf16 v[52:55], a[64:67], v[152:155], v[52:55]
    v_mfma_f32_16x16x32_bf16 v[56:59], a[68:71], v[152:155], v[56:59]
    v_mfma_f32_16x16x32_bf16 v[60:63], a[72:75], v[152:155], v[60:63]
    v_mfma_f32_16x16x32_bf16 v[64:67], a[76:79], v[152:155], v[64:67]
    buffer_load_dwordx4 v[140:143], v91, s[36:39], s26 offen
    buffer_load_dwordx4 v[128:131], v88, s[36:39], s26 offen
    s_add_u32 s26, s26, 4096
    s_waitcnt vmcnt(25)
    v_mfma_f32_16x16x32_bf16 v[68:71], a[60:63], v[156:159], v[68:71]
    v_mfma_f32_16x16x32_bf16 v[72:75], a[64:67], v[156:159], v[72:75]
    v_mfma_f32_16x16x32_bf16 v[76:79], a[68:71], v[156:159], v[76:79]
    v_mfma_f32_16x16x32_bf16 v[80:83], a[72:75], v[156:159], v[80:83]
    v_mfma_f32_16x16x32_bf16 v[84:87], a[76:79], v[156:159], v[84:87]
    buffer_load_dwordx4 v[148:151], v89, s[36:39], s26 offen
    buffer_load_dwordx4 v[152:155], v90, s[36:39], s26 offen
    s_waitcnt vmcnt(26)
    v_mfma_f32_16x16x32_bf16 v[8:11], a[60:63], v[144:147], v[8:11]
    v_mfma_f32_16x16x32_bf16 v[12:15], a[64:67], v[144:147], v[12:15]
    v_mfma_f32_16x16x32_bf16 v[16:19], a[68:71], v[144:147], v[16:19]
    v_mfma_f32_16x16x32_bf16 v[20:23], a[72:75], v[144:147], v[20:23]
    v_mfma_f32_16x16x32_bf16 v[24:27], a[76:79], v[144:147], v[24:27]
    buffer_load_dwordx4 v[156:159], v91, s[36:39], s26 offen
    buffer_load_dwordx4 v[144:147], v88, s[36:39], s26 offen
    s_add_u32 s26, s26, 4096
    s_waitcnt vmcnt(27)
    v_mfma_f32_16x16x32_bf16 v[28:31], a[80:83], v[164:167], v[28:31]
    v_mfma_f32_16x16x32_bf16 v[32:35], a[84:87], v[164:167], v[32:35]
    v_mfma_f32_16x16x32_bf16 v[36:39], a[88:91], v[164:167], v[36:39]
    v_mfma_f32_16x16x32_bf16 v[40:43], a[92:95], v[164:167], v[40:43]
    v_mfma_f32_16x16x32_bf16 v[44:47], a[96:99], v[164:167], v[44:47]
    buffer_load_dwordx4 v[164:167], v89, s[36:39], s26 offen
    s_waitcnt vmcnt(27)
    v_mfma_f32_16x16x32_bf16 v[48:51], a[80:83], v[168:171], v[48:51]
    v_mfma_f32_16x16x32_bf16 v[52:55], a[84:87], v[168:171], v[52:55]
    v_mfma_f32_16x16x32_bf16 v[56:59], a[88:91], v[168:171], v[56:59]
    v_mfma_f32_16x16x32_bf16 v[60:63], a[92:95], v[168:171], v[60:63]
    v_mfma_f32_16x16x32_bf16 v[64:67], a[96:99], v[168:171], v[64:67]
    buffer_load_dwordx4 v[168:171], v90, s[36:39], s26 offen
    s_waitcnt vmcnt(27)
    v_mfma_f32_16x16x32_bf16 v[68:71], a[80:83], v[172:175], v[68:71]
    v_mfma_f32_16x16x32_bf16 v[72:75], a[84:87], v[172:175], v[72:75]
    v_mfma_f32_16x16x32_bf16 v[76:79], a[88:91], v[172:175], v[76:79]
    v_mfma_f32_16x16x32_bf16 v[80:83], a[92:95], v[172:175], v[80:83]
    v_mfma_f32_16x16x32_bf16 v[84:87], a[96:99], v[172:175], v[84:87]
    buffer_load_dwordx4 v[172:175], v91, s[36:39], s26 offen
    s_waitcnt vmcnt(27)
    v_mfma_f32_16x16x32_bf16 v[8:11], a[80:83], v[160:163], v[8:11]
    v_mfma_f32_16x16x32_bf16 v[12:15], a[84:87], v[160:163], v[12:15]
    v_mfma_f32_16x16x32_bf16 v[16:19], a[88:91], v[160:163], v[16:19]
    v_mfma_f32_16x16x32_bf16 v[20:23], a[92:95], v[160:163], v[20:23]
    v_mfma_f32_16x16x32_bf16 v[24:27], a[96:99], v[160:163], v[24:27]
    buffer_load_dwordx4 v[160:163], v88, s[36:39], s26 offen
    s_add_u32 s26, s26, 4096
    s_waitcnt vmcnt(27)
    v_mfma_f32_16x16x32_bf16 v[28:31], a[100:103], v[180:183], v[28:31]
    v_mfma_f32_16x16x32_bf16 v[32:35], a[104:107], v[180:183], v[32:35]
    v_mfma_f32_16x16x32_bf16 v[36:39], a[108:111], v[180:183], v[36:39]
    v_mfma_f32_16x16x32_bf16 v[40:43], a[112:115], v[180:183], v[40:43]
    v_mfma_f32_16x16x32_bf16 v[44:47], a[116:119], v[180:183], v[44:47]
    buffer_load_dwordx4 v[180:183], v89, s[36:39], s26 offen
    s_waitcnt vmcnt(27)
    v_mfma_f32_16x16x32_bf16 v[48:51], a[100:103], v[184:187], v[48:51]
    v_mfma_f32_16x16x32_bf16 v[52:55], a[104:107], v[184:187], v[52:55]
    v_mfma_f32_16x16x32_bf16 v[56:59], a[108:111], v[184:187], v[56:59]
    v_mfma_f32_16x16x32_bf16 v[60:63], a[112:115], v[184:187], v[60:63]
    v_mfma_f32_16x16x32_bf16 v[64:67], a[116:119], v[184:187], v[64:67]
    buffer_load_dwordx4 v[184:187], v90, s[36:39], s26 offen
    s_waitcnt vmcnt(27)
    v_mfma_f32_16x16x32_bf16 v[68:71], a[100:103], v[188:191], v[68:71]
    v_mfma_f32_16x16x32_bf16 v[72:75], a[104:107], v[188:191], v[72:75]
    v_mfma_f32_16x16x32_bf16 v[76:79], a[108:111], v[188:191], v[76:79]
    v_mfma_f32_16x16x32_bf16 v[80:83], a[112:115], v[188:191], v[80:83]
    v_mfma_f32_16x16x32_bf16 v[84:87], a[116:119], v[188:191], v[84:87]
    buffer_load_dwordx4 v[188:191], v91, s[36:39], s26 offen
    s_waitcnt vmcnt(27)
    v_mfma_f32_16x16x32_bf16 v[8:11], a[100:103], v[176:179], v[8:11]
    v_mfma_f32_16x16x32_bf16 v[12:15], a[104:107], v[176:179], v[12:15]
    v_mfma_f32_16x16x32_bf16 v[16:19], a[108:111], v[176:179], v[16:19]
    v_mfma_f32_16x16x32_bf16 v[20:23], a[112:115], v[176:179], v[20:23]
    v_mfma_f32_16x16x32_bf16 v[24:27], a[116:119], v[176:179], v[24:27]
    buffer_load_dwordx4 v[176:179], v88, s[36:39], s26 offen
    s_add_u32 s26, s26, 4096
    s_waitcnt vmcnt(27)
    v_mfma_f32_16x16x32_bf16 v[28:31], a[120:123], v[196:199], v[28:31]
    v_mfma_f32_16x16x32_bf16 v[32:35], a[124:127], v[196:199], v[32:35]
    v_mfma_f32_16x16x32_bf16 v[36:39], a[128:131], v[196:199], v[36:39]
    v_mfma_f32_16x16x32_bf16 v[40:43], a[132:135], v[196:199], v[40:43]
    v_mfma_f32_16x16x32_bf16 v[44:47], a[136:139], v[196:199], v[44:47]
    buffer_load_dwordx4 v[196:199], v89, s[36:39], s26 offen
    s_waitcnt vmcnt(27)
    v_mfma_f32_16x16x32_bf16 v[48:51], a[120:123], v[200:203], v[48:51]
    v_mfma_f32_16x16x32_bf16 v[52:55], a[124:127], v[200:203], v[52:55]
    v_mfma_f32_16x16x32_bf16 v[56:59], a[128:131], v[200:203], v[56:59]
    v_mfma_f32_16x16x32_bf16 v[60:63], a[132:135], v[200:203], v[60:63]
    v_mfma_f32_16x16x32_bf16 v[64:67], a[136:139], v[200:203], v[64:67]
    buffer_load_dwordx4 v[200:203], v90, s[36:39], s26 offen
    s_waitcnt vmcnt(27)
    v_mfma_f32_16x16x32_bf16 v[68:71], a[120:123], v[204:207], v[68:71]
    v_mfma_f32_16x16x32_bf16 v[72:75], a[124:127], v[204:207], v[72:75]
    v_mfma_f32_16x16x32_bf16 v[76:79], a[128:131], v[204:207], v[76:79]
    v_mfma_f32_16x16x32_bf16 v[80:83], a[132:135], v[204:207], v[80:83]
    v_mfma_f32_16x16x32_bf16 v[84:87], a[136:139], v[204:207], v[84:87]
    buffer_load_dwordx4 v[204:207], v91, s[36:39], s26 offen
    s_waitcnt vmcnt(27)
    v_mfma_f32_16x16x32_bf16 v[8:11], a[120:123], v[192:195], v[8:11]
    v_mfma_f32_16x16x32_bf16 v[12:15], a[124:127], v[192:195], v[12:15]
    v_mfma_f32_16x16x32_bf16 v[16:19], a[128:131], v[192:195], v[16:19]
    v_mfma_f32_16x16x32_bf16 v[20:23], a[132:135], v[192:195], v[20:23]
    v_mfma_f32_16x16x32_bf16 v[24:27], a[136:139], v[192:195], v[24:27]
    buffer_load_dwordx4 v[192:195], v88, s[36:39], s26 offen
    s_add_u32 s26, s26, 4096
    buffer_load_dwordx4 v[220:223], v92, s[28:31], s48 offen
    buffer_load_dwordx4 v[224:227], v93, s[28:31], s48 offen
    s_mov_b32 exec_hi, 0
    buffer_load_dwordx4 v[228:231], v94, s[28:31], s48 offen
    s_mov_b32 exec_hi, -1
    s_waitcnt vmcnt(30)
    v_mfma_f32_16x16x32_bf16 v[28:31], a[140:143], v[100:103], v[28:31]
    v_mfma_f32_16x16x32_bf16 v[32:35], a[144:147], v[100:103], v[32:35]
    v_mfma_f32_16x16x32_bf16 v[36:39], a[148:151], v[100:103], v[36:39]
    v_mfma_f32_16x16x32_bf16 v[40:43], a[152:155], v[100:103], v[40:43]
    v_mfma_f32_16x16x32_bf16 v[44:47], a[156:159], v[100:103], v[44:47]
    s_waitcnt vmcnt(29)
    v_mfma_f32_16x16x32_bf16 v[48:51], a[140:143], v[104:107], v[48:51]
    v_mfma_f32_16x16x32_bf16 v[52:55], a[144:147], v[104:107], v[52:55]
    v_mfma_f32_16x16x32_bf16 v[56:59], a[148:151], v[104:107], v[56:59]
    v_mfma_f32_16x16x32_bf16 v[60:63], a[152:155], v[104:107], v[60:63]
    v_mfma_f32_16x16x32_bf16 v[64:67], a[156:159], v[104:107], v[64:67]
    s_waitcnt vmcnt(28)
    v_mfma_f32_16x16x32_bf16 v[68:71], a[140:143], v[108:111], v[68:71]
    v_mfma_f32_16x16x32_bf16 v[72:75], a[144:147], v[108:111], v[72:75]
    v_mfma_f32_16x16x32_bf16 v[76:79], a[148:151], v[108:111], v[76:79]
    v_mfma_f32_16x16x32_bf16 v[80:83], a[152:155], v[108:111], v[80:83]
    v_mfma_f32_16x16x32_bf16 v[84:87], a[156:159], v[108:111], v[84:87]
    s_waitcnt vmcnt(27)
    v_mfma_f32_16x16x32_bf16 v[8:11], a[140:143], v[96:99], v[8:11]
    v_mfma_f32_16x16x32_bf16 v[12:15], a[144:147], v[96:99], v[12:15]
    v_mfma_f32_16x16x32_bf16 v[16:19], a[148:151], v[96:99], v[16:19]
    v_mfma_f32_16x16x32_bf16 v[20:23], a[152:155], v[96:99], v[20:23]
    v_mfma_f32_16x16x32_bf16 v[24:27], a[156:159], v[96:99], v[24:27]
    s_waitcnt vmcnt(26)
    v_mfma_f32_16x16x32_bf16 v[28:31], a[160:163], v[116:119], v[28:31]
    v_mfma_f32_16x16x32_bf16 v[32:35], a[164:167], v[116:119], v[32:35]
    v_mfma_f32_16x16x32_bf16 v[36:39], a[168:171], v[116:119], v[36:39]
    v_mfma_f32_16x16x32_bf16 v[40:43], a[172:175], v[116:119], v[40:43]
    v_mfma_f32_16x16x32_bf16 v[44:47], a[176:179], v[116:119], v[44:47]
    s_waitcnt vmcnt(25)
    v_mfma_f32_16x16x32_bf16 v[48:51], a[160:163], v[120:123], v[48:51]
    v_mfma_f32_16x16x32_bf16 v[52:55], a[164:167], v[120:123], v[52:55]
    v_mfma_f32_16x16x32_bf16 v[56:59], a[168:171], v[120:123], v[56:59]
    v_mfma_f32_16x16x32_bf16 v[60:63], a[172:175], v[120:123], v[60:63]
    v_mfma_f32_16x16x32_bf16 v[64:67], a[176:179], v[120:123], v[64:67]
    s_waitcnt vmcnt(24)
    v_mfma_f32_16x16x32_bf16 v[68:71], a[160:163], v[124:127], v[68:71]
    v_mfma_f32_16x16x32_bf16 v[72:75], a[164:167], v[124:127], v[72:75]
    v_mfma_f32_16x16x32_bf16 v[76:79], a[168:171], v[124:127], v[76:79]
    v_mfma_f32_16x16x32_bf16 v[80:83], a[172:175], v[124:127], v[80:83]
    v_mfma_f32_16x16x32_bf16 v[84:87], a[176:179], v[124:127], v[84:87]
    s_waitcnt vmcnt(23)
    v_mfma_f32_16x16x32_bf16 v[8:11], a[160:163], v[112:115], v[8:11]
    v_mfma_f32_16x16x32_bf16 v[12:15], a[164:167], v[112:115], v[12:15]
    v_mfma_f32_16x16x32_bf16 v[16:19], a[168:171], v[112:115], v[16:19]
    v_mfma_f32_16x16x32_bf16 v[20:23], a[172:175], v[112:115], v[20:23]
    v_mfma_f32_16x16x32_bf16 v[24:27], a[176:179], v[112:115], v[24:27]
    s_waitcnt vmcnt(22)
    v_mfma_f32_16x16x32_bf16 v[28:31], a[180:183], v[132:135], v[28:31]
    v_mfma_f32_16x16x32_bf16 v[32:35], a[184:187], v[132:135], v[32:35]
    v_mfma_f32_16x16x32_bf16 v[36:39], a[188:191], v[132:135], v[36:39]
    v_mfma_f32_16x16x32_bf16 v[40:43], a[192:195], v[132:135], v[40:43]
    v_mfma_f32_16x16x32_bf16 v[44:47], a[196:199], v[132:135], v[44:47]
    s_waitcnt vmcnt(21)
    v_mfma_f32_16x16x32_bf16 v[48:51], a[180:183], v[136:139], v[48:51]
    v_mfma_f32_16x16x32_bf16 v[52:55], a[184:187], v[136:139], v[52:55]
    v_mfma_f32_16x16x32_bf16 v[56:59], a[188:191], v[136:139], v[56:59]
    v_mfma_f32_16x16x32_bf16 v[60:63], a[192:195], v[136:139], v[60:63]
    v_mfma_f32_16x16x32_bf16 v[64:67], a[196:199], v[136:139], v[64:67]
    s_waitcnt vmcnt(20)
    v_mfma_f32_16x16x32_bf16 v[68:71], a[180:183], v[140:143], v[68:71]
    v_mfma_f32_16x16x32_bf16 v[72:75], a[184:187], v[140:143], v[72:75]
    v_mfma_f32_16x16x32_bf16 v[76:79], a[188:191], v[140:143], v[76:79]
    v_mfma_f32_16x16x32_bf16 v[80:83], a[192:195], v[140:143], v[80:83]
    v_mfma_f32_16x16x32_bf16 v[84:87], a[196:199], v[140:143], v[84:87]
    s_waitcnt vmcnt(19)
    v_mfma_f32_16x16x32_bf16 v[8:11], a[180:183], v[128:131], v[8:11]
    v_mfma_f32_16x16x32_bf16 v[12:15], a[184:187], v[128:131], v[12:15]
    v_mfma_f32_16x16x32_bf16 v[16:19], a[188:191], v[128:131], v[16:19]
    v_mfma_f32_16x16x32_bf16 v[20:23], a[192:195], v[128:131], v[20:23]
    v_mfma_f32_16x16x32_bf16 v[24:27], a[196:199], v[128:131], v[24:27]
    s_waitcnt vmcnt(18)
    v_mfma_f32_16x16x32_bf16 v[28:31], a[200:203], v[148:151], v[28:31]
    v_mfma_f32_16x16x32_bf16 v[32:35], a[204:207], v[148:151], v[32:35]
    v_mfma_f32_16x16x32_bf16 v[36:39], a[208:211], v[148:151], v[36:39]
    v_mfma_f32_16x16x32_bf16 v[40:43], a[212:215], v[148:151], v[40:43]
    v_mfma_f32_16x16x32_bf16 v[44:47], a[216:219], v[148:151], v[44:47]
    s_waitcnt vmcnt(14)
    v_mfma_f32_16x16x32_bf16 v[28:31], a[220:223], v[164:167], v[28:31]
    v_mfma_f32_16x16x32_bf16 v[32:35], a[224:227], v[164:167], v[32:35]
    v_mfma_f32_16x16x32_bf16 v[36:39], a[228:231], v[164:167], v[36:39]
    v_mfma_f32_16x16x32_bf16 v[40:43], a[232:235], v[164:167], v[40:43]
    v_mfma_f32_16x16x32_bf16 v[44:47], a[236:239], v[164:167], v[44:47]
    s_waitcnt vmcnt(10)
    v_mfma_f32_16x16x32_bf16 v[28:31], a[240:243], v[180:183], v[28:31]
    v_mfma_f32_16x16x32_bf16 v[32:35], a[244:247], v[180:183], v[32:35]
    v_mfma_f32_16x16x32_bf16 v[36:39], a[248:251], v[180:183], v[36:39]
    v_mfma_f32_16x16x32_bf16 v[40:43], a[252:255], v[180:183], v[40:43]
    v_mfma_f32_16x16x32_bf16 v[44:47], v[232:235], v[180:183], v[44:47]
    s_cmp_lt_u32 s20, 2
    s_nop 5
    s_cbranch_scc1 K5_skip1
    s_waitcnt vmcnt(6)
    v_mfma_f32_16x16x32_bf16 v[28:31], v[236:239], v[196:199], v[28:31]
    v_mfma_f32_16x16x32_bf16 v[32:35], v[240:243], v[196:199], v[32:35]
    v_mfma_f32_16x16x32_bf16 v[36:39], v[244:247], v[196:199], v[36:39]
    v_mfma_f32_16x16x32_bf16 v[40:43], v[248:251], v[196:199], v[40:43]
    v_mfma_f32_16x16x32_bf16 v[44:47], v[252:255], v[196:199], v[44:47]
K5_skip1:
    s_waitcnt vmcnt(17)
    v_mfma_f32_16x16x32_bf16 v[48:51], a[200:203], v[152:155], v[48:51]
    v_mfma_f32_16x16x32_bf16 v[52:55], a[204:207], v[152:155], v[52:55]
    v_add_u32 v5, s41, v95
    v_mfma_f32_16x16x32_bf16 v[56:59], a[208:211], v[152:155], v[56:59]
    v_mfma_f32_16x16x32_bf16 v[60:63], a[212:215], v[152:155], v[60:63]
    ds_write_b128 v5, v[28:31] offset:5280
    v_mfma_f32_16x16x32_bf16 v[64:67], a[216:219], v[152:155], v[64:67]
    s_waitcnt vmcnt(13)
    v_mfma_f32_16x16x32_bf16 v[48:51], a[220:223], v[168:171], v[48:51]
    v_mfma_f32_16x16x32_bf16 v[52:55], a[224:227], v[168:171], v[52:55]
    ds_write_b128 v5, v[32:35] offset:6336
    v_mfma_f32_16x16x32_bf16 v[56:59], a[228:231], v[168:171], v[56:59]
    v_mfma_f32_16x16x32_bf16 v[60:63], a[232:235], v[168:171], v[60:63]
    ds_write_b128 v5, v[36:39] offset:7392
    v_mfma_f32_16x16x32_bf16 v[64:67], a[236:239], v[168:171], v[64:67]
    s_waitcnt vmcnt(9)
    v_mfma_f32_16x16x32_bf16 v[48:51], a[240:243], v[184:187], v[48:51]
    v_mfma_f32_16x16x32_bf16 v[52:55], a[244:247], v[184:187], v[52:55]
    ds_write_b128 v5, v[40:43] offset:8448
    v_mfma_f32_16x16x32_bf16 v[56:59], a[248:251], v[184:187], v[56:59]
    v_mfma_f32_16x16x32_bf16 v[60:63], a[252:255], v[184:187], v[60:63]
    ds_write_b128 v5, v[44:47] offset:9504
    v_mfma_f32_16x16x32_bf16 v[64:67], v[232:235], v[184:187], v[64:67]
    s_cmp_lt_u32 s20, 2
    s_nop 5
    s_cbranch_scc1 K5_skip2
    s_waitcnt vmcnt(5)
    v_mfma_f32_16x16x32_bf16 v[48:51], v[236:239], v[200:203], v[48:51]
    v_mfma_f32_16x16x32_bf16 v[52:55], v[240:243], v[200:203], v[52:55]
    v_mfma_f32_16x16x32_bf16 v[56:59], v[244:247], v[200:203], v[56:59]
    v_mfma_f32_16x16x32_bf16 v[60:63], v[248:251], v[200:203], v[60:63]
    v_mfma_f32_16x16x32_bf16 v[64:67], v[252:255], v[200:203], v[64:67]
K5_skip2:
    s_waitcnt vmcnt(16)
    v_mfma_f32_16x16x32_bf16 v[68:71], a[200:203], v[156:159], v[68:71]
    v_mfma_f32_16x16x32_bf16 v[72:75], a[204:207], v[156:159], v[72:75]
    v_add_u32 v5, s42, v95
    v_mfma_f32_16x16x32_bf16 v[76:79], a[208:211], v[156:159], v[76:79]
    v_mfma_f32_16x16x32_bf16 v[80:83], a[212:215], v[156:159], v[80:83]
    ds_write_b128 v5, v[48:51] offset:10560
    v_mfma_f32_16x16x32_bf16 v[84:87], a[216:219], v[156:159], v[84:87]
    s_waitcnt vmcnt(12)
    v_mfma_f32_16x16x32_bf16 v[68:71], a[220:223], v[172:175], v[68:71]
    v_mfma_f32_16x16x32_bf16 v[72:75], a[224:227], v[172:175], v[72:75]
    ds_write_b128 v5, v[52:55] offset:11616
    v_mfma_f32_16x16x32_bf16 v[76:79], a[228:231], v[172:175], v[76:79]
    v_mfma_f32_16x16x32_bf16 v[80:83], a[232:235], v[172:175], v[80:83]
    ds_write_b128 v5, v[56:59] offset:12672
    v_mfma_f32_16x16x32_bf16 v[84:87], a[236:239], v[172:175], v[84:87]
    s_waitcnt vmcnt(8)
    v_mfma_f32_16x16x32_bf16 v[68:71], a[240:243], v[188:191], v[68:71]
    v_mfma_f32_16x16x32_bf16 v[72:75], a[244:247], v[188:191], v[72:75]
    ds_write_b128 v5, v[60:63] offset:13728
    v_mfma_f32_16x16x32_bf16 v[76:79], a[248:251], v[188:191], v[76:79]
    v_mfma_f32_16x16x32_bf16 v[80:83], a[252:255], v[188:191], v[80:83]
    ds_write_b128 v5, v[64:67] offset:14784
    v_mfma_f32_16x16x32_bf16 v[84:87], v[232:235], v[188:191], v[84:87]
    s_cmp_lt_u32 s20, 2
    s_nop 5
    s_cbranch_scc1 K5_skip3
    s_waitcnt vmcnt(4)
    v_mfma_f32_16x16x32_bf16 v[68:71], v[236:239], v[204:207], v[68:71]
    v_mfma_f32_16x16x32_bf16 v[72:75], v[240:243], v[204:207], v[72:75]
    v_mfma_f32_16x16x32_bf16 v[76:79], v[244:247], v[204:207], v[76:79]
    v_mfma_f32_16x16x32_bf16 v[80:83], v[248:251], v[204:207], v[80:83]
    v_mfma_f32_16x16x32_bf16 v[84:87], v[252:255], v[204:207], v[84:87]
K5_skip3:
    s_waitcnt vmcnt(15)
    v_mfma_f32_16x16x32_bf16 v[8:11], a[200:203], v[144:147], v[8:11]
    v_mfma_f32_16x16x32_bf16 v[12:15], a[204:207], v[144:147], v[12:15]
    v_add_u32 v5, s43, v95
    v_mfma_f32_16x16x32_bf16 v[16:19], a[208:211], v[144:147], v[16:19]
    v_mfma_f32_16x16x32_bf16 v[20:23], a[212:215], v[144:147], v[20:23]
    ds_write_b128 v5, v[68:71] offset:15840
    v_mfma_f32_16x16x32_bf16 v[24:27], a[216:219], v[144:147], v[24:27]
    s_waitcnt vmcnt(11)
    v_mfma_f32_16x16x32_bf16 v[8:11], a[220:223], v[160:163], v[8:11]
    v_mfma_f32_16x16x32_bf16 v[12:15], a[224:227], v[160:163], v[12:15]
    ds_write_b128 v5, v[72:75] offset:16896
    v_mfma_f32_16x16x32_bf16 v[16:19], a[228:231], v[160:163], v[16:19]
    v_mfma_f32_16x16x32_bf16 v[20:23], a[232:235], v[160:163], v[20:23]
    ds_write_b128 v5, v[76:79] offset:17952
    v_mfma_f32_16x16x32_bf16 v[24:27], a[236:239], v[160:163], v[24:27]
    s_waitcnt vmcnt(7)
    v_mfma_f32_16x16x32_bf16 v[8:11], a[240:243], v[176:179], v[8:11]
    v_mfma_f32_16x16x32_bf16 v[12:15], a[244:247], v[176:179], v[12:15]
    ds_write_b128 v5, v[80:83] offset:19008
    v_mfma_f32_16x16x32_bf16 v[16:19], a[248:251], v[176:179], v[16:19]
    v_mfma_f32_16x16x32_bf16 v[20:23], a[252:255], v[176:179], v[20:23]
    ds_write_b128 v5, v[84:87] offset:20064
    v_mfma_f32_16x16x32_bf16 v[24:27], v[232:235], v[176:179], v[24:27]
    s_cmp_lt_u32 s20, 2
    s_nop 5
    s_cbranch_scc1 K5_skip0
    s_waitcnt vmcnt(3)
    v_mfma_f32_16x16x32_bf16 v[8:11], v[236:239], v[192:195], v[8:11]
    v_mfma_f32_16x16x32_bf16 v[12:15], v[240:243], v[192:195], v[12:15]
    v_mfma_f32_16x16x32_bf16 v[16:19], v[244:247], v[192:195], v[16:19]
    v_mfma_f32_16x16x32_bf16 v[20:23], v[248:251], v[192:195], v[20:23]
    v_mfma_f32_16x16x32_bf16 v[24:27], v[252:255], v[192:195], v[24:27]
K5_skip0:
    v_add_u32 v5, s40, v95
    s_nop 2
    ds_write_b128 v5, v[8:11] offset:0
    ds_write_b128 v5, v[12:15] offset:1056
    ds_write_b128 v5, v[16:19] offset:2112
    ds_write_b128 v5, v[20:23] offset:3168
    ds_write_b128 v5, v[24:27] offset:4224
K5_red:
    s_waitcnt vmcnt(0)
    v_lshlrev_b32 v232, 16, v220
    v_and_b32 v233, 0xffff0000, v220
    v_lshlrev_b32 v6, 16, v208
    v_and_b32 v7, 0xffff0000, v208
    v_pk_add_f32 v[232:233], v[232:233], v[6:7]
    v_lshlrev_b32 v234, 16, v221
    v_and_b32 v235, 0xffff0000, v221
    v_lshlrev_b32 v6, 16, v209
    v_and_b32 v7, 0xffff0000, v209
    v_pk_add_f32 v[234:235], v[234:235], v[6:7]
    v_lshlrev_b32 v236, 16, v222
    v_and_b32 v237, 0xffff0000, v222
    v_lshlrev_b32 v6, 16, v210
    v_and_b32 v7, 0xffff0000, v210
    v_pk_add_f32 v[236:237], v[236:237], v[6:7]
    v_lshlrev_b32 v238, 16, v223
    v_and_b32 v239, 0xffff0000, v223
    v_lshlrev_b32 v6, 16, v211
    v_and_b32 v7, 0xffff0000, v211
    v_pk_add_f32 v[238:239], v[238:239], v[6:7]
    v_lshlrev_b32 v240, 16, v224
    v_and_b32 v241, 0xffff0000, v224
    v_lshlrev_b32 v6, 16, v212
    v_and_b32 v7, 0xffff0000, v212
    v_pk_add_f32 v[240:241], v[240:241], v[6:7]
    v_lshlrev_b32 v242, 16, v225
    v_and_b32 v243, 0xffff0000, v225
    v_lshlrev_b32 v6, 16, v213
    v_and_b32 v7, 0xffff0000, v213
    v_pk_add_f32 v[242:243], v[242:243], v[6:7]
    v_lshlrev_b32 v244, 16, v226
    v_and_b32 v245, 0xffff0000, v226
    v_lshlrev_b32 v6, 16, v214
    v_and_b32 v7, 0xffff0000, v214
    v_pk_add_f32 v[244:245], v[244:245], v[6:7]
    v_lshlrev_b32 v246, 16, v227
    v_and_b32 v247, 0xffff0000, v227
    v_lshlrev_b32 v6, 16, v215
    v_and_b32 v7, 0xffff0000, v215
    v_pk_add_f32 v[246:247], v[246:247], v[6:7]
    v_lshlrev_b32 v248, 16, v228
    v_and_b32 v249, 0xffff0000, v228
    v_lshlrev_b32 v6, 16, v216
    v_and_b32 v7, 0xffff0000, v216
    v_pk_add_f32 v[248:249], v[248:249], v[6:7]
    v_lshlrev_b32 v250, 16, v229
    v_and_b32 v251, 0xffff0000, v229
    v_lshlrev_b32 v6, 16, v217
    v_and_b32 v7, 0xffff0000, v217
    v_pk_add_f32 v[250:251], v[250:251], v[6:7]
    v_lshlrev_b32 v252, 16, v230
    v_and_b32 v253, 0xffff0000, v230
    v_lshlrev_b32 v6, 16, v218
    v_and_b32 v7, 0xffff0000, v218
    v_pk_add_f32 v[252:253], v[252:253], v[6:7]
    v_lshlrev_b32 v254, 16, v231
    v_and_b32 v255, 0xffff0000, v231
    v_lshlrev_b32 v6, 16, v219
    v_and_b32 v7, 0xffff0000, v219
    v_pk_add_f32 v[254:255], v[254:255], v[6:7]
    s_waitcnt lgkmcnt(0)
    s_barrier
    ds_read_b128 v[96:99], v2 offset:0
    ds_read_b128 v[100:103], v2 offset:256
    ds_read_b128 v[104:107], v2 offset:5280
    ds_read_b128 v[108:111], v2 offset:5536
    ds_read_b128 v[112:115], v2 offset:10560
    ds_read_b128 v[116:119], v2 offset:10816
    ds_read_b128 v[120:123], v2 offset:15840
    ds_read_b128 v[124:127], v2 offset:16096
    ds_read_b128 v[128:131], v3 offset:0
    ds_read_b128 v[132:135], v3 offset:256
    ds_read_b128 v[136:139], v3 offset:5280
    ds_read_b128 v[140:143], v3 offset:5536
    ds_read_b128 v[144:147], v3 offset:10560
    ds_read_b128 v[148:151], v3 offset:10816
    ds_read_b128 v[152:155], v3 offset:15840
    ds_read_b128 v[156:159], v3 offset:16096
    s_mov_b32 exec_hi, 0
    ds_read_b128 v[160:163], v4 offset:0
    ds_read_b128 v[164:167], v4 offset:256
    ds_read_b128 v[168:171], v4 offset:5280
    ds_read_b128 v[172:175], v4 offset:5536
    ds_read_b128 v[176:179], v4 offset:10560
    ds_read_b128 v[180:183], v4 offset:10816
    ds_read_b128 v[184:187], v4 offset:15840
    ds_read_b128 v[188:191], v4 offset:16096
    s_mov_b32 exec_hi, -1
    s_waitcnt lgkmcnt(15)
    v_pk_add_f32 v[96:97], v[96:97], v[104:105]
    v_pk_add_f32 v[98:99], v[98:99], v[106:107]
    v_pk_add_f32 v[100:101], v[100:101], v[108:109]
    v_pk_add_f32 v[102:103], v[102:103], v[110:111]
    s_waitcnt lgkmcnt(15)
    v_pk_add_f32 v[112:113], v[112:113], v[120:121]
    v_pk_add_f32 v[114:115], v[114:115], v[122:123]
    v_pk_add_f32 v[116:117], v[116:117], v[124:125]
    v_pk_add_f32 v[118:119], v[118:119], v[126:127]
    v_pk_add_f32 v[232:233], v[232:233], v[96:97]
    v_pk_add_f32 v[234:235], v[234:235], v[98:99]
    v_pk_add_f32 v[236:237], v[236:237], v[100:101]
    v_pk_add_f32 v[238:239], v[238:239], v[102:103]
    v_pk_add_f32 v[232:233], v[232:233], v[112:113]
    v_pk_add_f32 v[234:235], v[234:235], v[114:115]
    v_pk_add_f32 v[236:237], v[236:237], v[116:117]
    v_pk_add_f32 v[238:239], v[238:239], v[118:119]
    v_cvt_pk_bf16_f32 v96, v232, v233
    v_cvt_pk_bf16_f32 v97, v234, v235
    v_cvt_pk_bf16_f32 v98, v236, v237
    v_cvt_pk_bf16_f32 v99, v238, v239
    buffer_store_dwordx4 v[96:99], v92, s[44:47], s48 offen nt
    s_waitcnt lgkmcnt(12)
    v_pk_add_f32 v[128:129], v[128:129], v[136:137]
    v_pk_add_f32 v[130:131], v[130:131], v[138:139]
    v_pk_add_f32 v[132:133], v[132:133], v[140:141]
    v_pk_add_f32 v[134:135], v[134:135], v[142:143]
    s_waitcnt lgkmcnt(8)
    v_pk_add_f32 v[144:145], v[144:145], v[152:153]
    v_pk_add_f32 v[146:147], v[146:147], v[154:155]
    v_pk_add_f32 v[148:149], v[148:149], v[156:157]
    v_pk_add_f32 v[150:151], v[150:151], v[158:159]
    v_pk_add_f32 v[240:241], v[240:241], v[128:129]
    v_pk_add_f32 v[242:243], v[242:243], v[130:131]
    v_pk_add_f32 v[244:245], v[244:245], v[132:133]
    v_pk_add_f32 v[246:247], v[246:247], v[134:135]
    v_pk_add_f32 v[240:241], v[240:241], v[144:145]
    v_pk_add_f32 v[242:243], v[242:243], v[146:147]
    v_pk_add_f32 v[244:245], v[244:245], v[148:149]
    v_pk_add_f32 v[246:247], v[246:247], v[150:151]
    v_cvt_pk_bf16_f32 v128, v240, v241
    v_cvt_pk_bf16_f32 v129, v242, v243
    v_cvt_pk_bf16_f32 v130, v244, v245
    v_cvt_pk_bf16_f32 v131, v246, v247
    buffer_store_dwordx4 v[128:131], v93, s[44:47], s48 offen nt
    s_mov_b32 exec_hi, 0
    s_waitcnt lgkmcnt(4)
    v_pk_add_f32 v[160:161], v[160:161], v[168:169]
    v_pk_add_f32 v[162:163], v[162:163], v[170:171]
    v_pk_add_f32 v[164:165], v[164:165], v[172:173]
    v_pk_add_f32 v[166:167], v[166:167], v[174:175]
    s_waitcnt lgkmcnt(0)
    v_pk_add_f32 v[176:177], v[176:177], v[184:185]
    v_pk_add_f32 v[178:179], v[178:179], v[186:187]
    v_pk_add_f32 v[180:181], v[180:181], v[188:189]
    v_pk_add_f32 v[182:183], v[182:183], v[190:191]
    v_pk_add_f32 v[248:249], v[248:249], v[160:161]
    v_pk_add_f32 v[250:251], v[250:251], v[162:163]
    v_pk_add_f32 v[252:253], v[252:253], v[164:165]
    v_pk_add_f32 v[254:255], v[254:255], v[166:167]
    v_pk_add_f32 v[248:249], v[248:249], v[176:177]
    v_pk_add_f32 v[250:251], v[250:251], v[178:179]
    v_pk_add_f32 v[252:253], v[252:253], v[180:181]
    v_pk_add_f32 v[254:255], v[254:255], v[182:183]
    v_cvt_pk_bf16_f32 v160, v248, v249
    v_cvt_pk_bf16_f32 v161, v250, v251
    v_cvt_pk_bf16_f32 v162, v252, v253
    v_cvt_pk_bf16_f32 v163, v254, v255
    buffer_store_dwordx4 v[160:163], v94, s[44:47], s48 offen nt
    s_mov_b32 exec_hi, -1
KF_end:
    s_endpgm
CODE_END:
    s_endpgm
.section .rodata,"a"
.p2align 6
.amdhsa_kernel k1_kernel
  .amdhsa_next_free_vgpr 168
  .amdhsa_next_free_sgpr 98
  .amdhsa_accum_offset 168
  .amdhsa_group_segment_fixed_size 0
  .amdhsa_kernarg_size 88
  .amdhsa_user_sgpr_count 2
  .amdhsa_user_sgpr_kernarg_segment_ptr 1
  .amdhsa_system_sgpr_workgroup_id_x 1
.end_amdhsa_kernel
.section .rodata,"a"
.p2align 6
.amdhsa_kernel kf_kernel
  .amdhsa_next_free_vgpr 512
  .amdhsa_next_free_sgpr 100
  .amdhsa_accum_offset 256
  .amdhsa_group_segment_fixed_size 0
  .amdhsa_kernarg_size 88
  .amdhsa_user_sgpr_count 2
  .amdhsa_user_sgpr_kernarg_segment_ptr 1
  .amdhsa_system_sgpr_workgroup_id_x 1
.end_amdhsa_kernel
```
